```python
import torch

def _softmax(x, axis=-1):
    return torch.softmax(x, dim=axis)
def _gelu(x):
    return torch.nn.functional.gelu(x, approximate="tanh")
def _silu(x):
    return torch.nn.functional.silu(x)
def _sigmoid(x):
    return torch.sigmoid(x)
def _layernorm(x, axis=-1, eps=1e-5):
    m = x.mean(dim=axis, keepdim=True)
    v = x.var(dim=axis, keepdim=True, unbiased=False)
    return (x - m) / torch.sqrt(v + eps)
def _scatter_add(tgt, idx, src, axis=0):
    return tgt.clone().index_add_(axis, idx, src)
def _segment_sum(src, seg, n):
    out = torch.zeros((n,) + src.shape[1:], dtype=src.dtype)
    return out.index_add_(0, seg, src)
def _pad(x, pw):
    flat = tuple(v for pair in reversed(pw) for v in pair)
    return torch.nn.functional.pad(x, flat)

kernel_name = 'gated_mix__sliding_local_dilated__mixer_token_mlp__prompt'

def setup_inputs():

    _w = (lambda a: (lambda t: t.to(torch.bfloat16) if t.is_floating_point() else t)(torch.as_tensor(a)))
    def _A_setup():
        B, S, D = 1, 2048, 512
        return {
            "x": _w((lambda *s: torch.randn(*s, dtype=torch.bfloat16) * 0.05)(B, S, D)),
            "wqkv": _w((lambda *s: torch.randn(*s, dtype=torch.bfloat16) * 0.8)(D, 3 * D)),
            "wo": _w((lambda *s: torch.randn(*s, dtype=torch.bfloat16) * 0.05)(D, D)),
        }
    _A_in = _A_setup()

    def _B_setup():
        B, S, D, F = 1, 2048, 512, 1792
        return {
            "x": _w((lambda *s: torch.randn(*s, dtype=torch.bfloat16) * 0.05)(B, S, D)),
            "w1": _w((lambda *s: torch.randn(*s, dtype=torch.bfloat16) * 1.6)(S, F) * (S ** -0.5)),
            "b1": _w((lambda *s: torch.randn(*s, dtype=torch.bfloat16) * 12.8)(F) * 0.02),
            "w2": _w((lambda *s: torch.randn(*s, dtype=torch.bfloat16) * 0.4)(F, S) * (F ** -0.5)),
            "b2": _w((lambda *s: torch.randn(*s, dtype=torch.bfloat16) * 6.4)(S) * 0.02),
        }
    _B_in = _B_setup()

    return {
        "A_x": _A_in["x"],
        "A_wqkv": _A_in["wqkv"],
        "A_wo": _A_in["wo"],
        "B_x": _B_in["x"],
        "B_w1": _B_in["w1"],
        "B_b1": _B_in["b1"],
        "B_w2": _B_in["w2"],
        "B_b2": _B_in["b2"],
        "gate_w": _w((lambda *s: torch.randn(*s, dtype=torch.bfloat16) * 0.05)(512) * 16.0),
    }

def reference(A_x, A_wqkv, A_wo, B_x, B_w1, B_b1, B_w2, B_b2, gate_w):
    def _A_ref(x, wqkv, wo):
        B, S, D = x.shape
        H = 32; Dh = D // H
        W, dil = 8, 2
        qkv = (lambda x, *d: x.permute(*d))((x @ wqkv).reshape(B, S, 3, H, Dh), 2, 0, 3, 1, 4)
        q, k, v = qkv[0], qkv[1], qkv[2]
        scale = Dh ** -0.5
        pos = torch.arange(S)
        off = torch.arange(W) * dil
        idx = pos[:, None] - off[None, :]
        mask = idx >= 0
        idx_c = torch.where(mask, idx, 0).reshape(-1)
        kg = k[:, :, idx_c, :].reshape(B, H, S, W, Dh)
        vg = v[:, :, idx_c, :].reshape(B, H, S, W, Dh)
        logits = torch.einsum("bhsd,bhswd->bhsw", q, kg) * scale
        logits = torch.where(mask[None, None, :, :], logits, -1e9)
        attn = _softmax(logits, axis=-1)
        o = torch.einsum("bhsw,bhswd->bhsd", attn, vg)
        return (lambda x, *d: x.permute(*d))(o, 0, 2, 1, 3).reshape(B, S, D) @ wo

    def _B_ref(x, w1, b1, w2, b2):
        B, S, D = x.shape
        h = _layernorm(x, axis=-1)
        u = torch.einsum("bsd,sf->bdf", h, w1) + b1
        u = _gelu(u)
        y = torch.einsum("bdf,fs->bds", u, w2) + b2
        return (lambda x, *d: x.permute(*d))(y, 0, 2, 1)

    x = A_x
    g = _sigmoid((x * gate_w).sum(-1, keepdims=True))
    a = _A_ref(x, A_wqkv, A_wo)
    b = _B_ref(x, B_w1, B_b1, B_w2, B_b2)
    return g * a + (1 - g) * b
```

```asm
; @launch grid=(256,1,1) block=(512,1,1) lds=156736
.amdgcn_target "amdgcn-amd-amdhsa--gfx950"
.text
.globl gated_mix__sliding_local_dilated__mixer_token_mlp__prompt_kernel
.p2align 8
.type gated_mix__sliding_local_dilated__mixer_token_mlp__prompt_kernel,@function
gated_mix__sliding_local_dilated__mixer_token_mlp__prompt_kernel:
    s_cmp_ge_u32 s2, 256
    s_cbranch_scc1 F_END
    s_load_dwordx16 s[4:19], s[0:1], 0
    s_load_dwordx8 s[20:27], s[0:1], 64
    v_lshrrev_b32 v2, 6, v0
    v_and_b32 v1, 63, v0
    v_readfirstlane_b32 s28, v2
    s_and_b32 s33, s2, 3
    s_lshl_b32 s33, s33, 3
    s_bfe_u32 s31, s2, 0x30003
    s_add_u32 s33, s33, s31
    s_lshl_b32 s33, s33, 6
    s_bfe_u32 s34, s2, 0x10002
    s_lshl_b32 s34, s34, 2
    s_lshr_b32 s31, s2, 6
    s_add_u32 s34, s34, s31
    s_and_b32 s35, s2, 1
    s_lshl_b32 s35, s35, 2
    s_bfe_u32 s31, s2, 0x20003
    s_add_u32 s35, s35, s31
    s_bfe_u32 s32, s2, 0x20001
    s_mul_i32 s36, s32, 7
    s_lshr_b32 s31, s2, 5
    s_add_u32 s36, s36, s31
    s_lshl_b32 s37, s32, 3
    s_add_u32 s37, s37, s31
    s_lshr_b32 s38, s2, 3
    s_and_b32 s29, s28, 3
    s_waitcnt lgkmcnt(0)
    s_add_u32 s44, s26, 0x700000
    s_addc_u32 s45, s27, 0
    s_and_b32 s45, s45, 0xffff
    s_mov_b32 s46, 0x20000
    s_mov_b32 s47, 0x20000
    s_cmp_lt_u32 s28, 4
    s_cbranch_scc1 F_CONS
    s_mov_b32 s48, s4
    s_and_b32 s49, s5, 0xffff
    s_mov_b32 s50, 0x200000
    s_mov_b32 s51, 0x20000
    s_mov_b32 s52, s6
    s_and_b32 s53, s7, 0xffff
    s_mov_b32 s54, 0x180000
    s_mov_b32 s55, 0x20000
    s_and_b32 s30, s29, 1
    s_lshl_b32 s30, s30, 2
    v_lshrrev_b32 v2, 4, v1
    v_add_u32 v2, s30, v2
    v_and_b32 v4, 7, v1
    v_xor_b32 v4, v4, v2
    v_lshlrev_b32 v4, 4, v4
    v_mov_b32 v7, v4
    v_lshrrev_b32 v2, 3, v1
    s_lshl_b32 s31, s29, 3
    s_add_u32 s31, s31, s33
    s_sub_u32 s31, s31, 32
    v_add_u32 v3, s31, v2
    v_max_i32 v3, 0, v3
    v_lshl_add_u32 v5, v3, 10, v4
    v_lshl_add_u32 v4, v2, 10, v4
    v_bfe_u32 v2, v1, 4, 1
    v_lshlrev_b32 v2, 2, v2
    v_and_b32 v6, 7, v1
    v_xor_b32 v6, v6, v2
    v_lshlrev_b32 v6, 4, v6
    v_lshrrev_b32 v2, 3, v1
    s_mov_b32 s32, 3072
    v_mul_lo_u32 v2, v2, s32
    v_add_u32 v6, v6, v2
    s_add_u32 s64, s31, 32
    s_lshl_b32 s64, s64, 10
    s_mul_i32 s65, s29, 24576
    s_lshl_b32 s31, s34, 7
    s_add_u32 s65, s65, s31
    s_lshl_b32 s66, s29, 10
    s_lshr_b32 s69, s38, 3
    s_lshl_b32 s69, s69, 1
    s_add_u32 s69, s69, s38
    s_and_b32 s69, s69, 7
    s_lshl_b32 s67, s69, 7
    s_mul_i32 s31, s69, 196608
    s_add_u32 s65, s65, s31
    s_mov_b32 s68, 0
    s_add_u32 m0, s68, s66
    s_add_u32 s31, s64, s67
    buffer_load_dwordx4 v5, s[48:51], s67 offen lds
    s_add_u32 m0, m0, 4096
    s_add_u32 s32, s31, 32768
    buffer_load_dwordx4 v4, s[48:51], s31 offen lds
    s_add_u32 m0, m0, 4096
    s_add_u32 s67, s67, 128
    buffer_load_dwordx4 v4, s[48:51], s32 offen lds
    s_add_u32 m0, m0, 4096
    s_add_u32 s31, s65, 0
    buffer_load_dwordx4 v6, s[52:55], s31 offen lds
    s_add_u32 m0, m0, 4096
    s_add_u32 s31, s65, 98304
    buffer_load_dwordx4 v6, s[52:55], s31 offen lds
    s_add_u32 m0, m0, 4096
    s_add_u32 s31, s65, 1024
    buffer_load_dwordx4 v6, s[52:55], s31 offen lds
    s_add_u32 m0, m0, 4096
    s_add_u32 s31, s65, 99328
    buffer_load_dwordx4 v6, s[52:55], s31 offen lds
    s_add_u32 m0, m0, 4096
    s_add_u32 s31, s65, 2048
    buffer_load_dwordx4 v6, s[52:55], s31 offen lds
    s_add_u32 m0, m0, 4096
    s_add_u32 s31, s65, 100352
    buffer_load_dwordx4 v6, s[52:55], s31 offen lds
    s_add_u32 s65, s65, 196608
    s_cmp_eq_u32 s67, 1024
    s_cselect_b32 s31, 1572864, 0
    s_cselect_b32 s67, 0, s67
    s_sub_u32 s65, s65, s31
    s_add_u32 s68, s68, 36864
    s_cmp_eq_u32 s68, 147456
    s_cselect_b32 s68, 0, s68
    s_add_u32 m0, s68, s66
    s_add_u32 s31, s64, s67
    buffer_load_dwordx4 v5, s[48:51], s67 offen lds
    s_add_u32 m0, m0, 4096
    s_add_u32 s32, s31, 32768
    buffer_load_dwordx4 v4, s[48:51], s31 offen lds
    s_add_u32 m0, m0, 4096
    s_add_u32 s67, s67, 128
    buffer_load_dwordx4 v4, s[48:51], s32 offen lds
    s_add_u32 m0, m0, 4096
    s_add_u32 s31, s65, 0
    buffer_load_dwordx4 v6, s[52:55], s31 offen lds
    s_add_u32 m0, m0, 4096
    s_add_u32 s31, s65, 98304
    buffer_load_dwordx4 v6, s[52:55], s31 offen lds
    s_add_u32 m0, m0, 4096
    s_add_u32 s31, s65, 1024
    buffer_load_dwordx4 v6, s[52:55], s31 offen lds
    s_add_u32 m0, m0, 4096
    s_add_u32 s31, s65, 99328
    buffer_load_dwordx4 v6, s[52:55], s31 offen lds
    s_add_u32 m0, m0, 4096
    s_add_u32 s31, s65, 2048
    buffer_load_dwordx4 v6, s[52:55], s31 offen lds
    s_add_u32 m0, m0, 4096
    s_add_u32 s31, s65, 100352
    buffer_load_dwordx4 v6, s[52:55], s31 offen lds
    s_add_u32 s65, s65, 196608
    s_cmp_eq_u32 s67, 1024
    s_cselect_b32 s31, 1572864, 0
    s_cselect_b32 s67, 0, s67
    s_sub_u32 s65, s65, s31
    s_add_u32 s68, s68, 36864
    s_cmp_eq_u32 s68, 147456
    s_cselect_b32 s68, 0, s68
    s_add_u32 m0, s68, s66
    s_add_u32 s31, s64, s67
    buffer_load_dwordx4 v5, s[48:51], s67 offen lds
    s_add_u32 m0, m0, 4096
    s_add_u32 s32, s31, 32768
    buffer_load_dwordx4 v4, s[48:51], s31 offen lds
    s_add_u32 m0, m0, 4096
    s_add_u32 s67, s67, 128
    buffer_load_dwordx4 v4, s[48:51], s32 offen lds
    s_add_u32 m0, m0, 4096
    s_add_u32 s31, s65, 0
    buffer_load_dwordx4 v6, s[52:55], s31 offen lds
    s_add_u32 m0, m0, 4096
    s_add_u32 s31, s65, 98304
    buffer_load_dwordx4 v6, s[52:55], s31 offen lds
    s_add_u32 m0, m0, 4096
    s_add_u32 s31, s65, 1024
    buffer_load_dwordx4 v6, s[52:55], s31 offen lds
    s_add_u32 m0, m0, 4096
    s_add_u32 s31, s65, 99328
    buffer_load_dwordx4 v6, s[52:55], s31 offen lds
    s_add_u32 m0, m0, 4096
    s_add_u32 s31, s65, 2048
    buffer_load_dwordx4 v6, s[52:55], s31 offen lds
    s_add_u32 m0, m0, 4096
    s_add_u32 s31, s65, 100352
    buffer_load_dwordx4 v6, s[52:55], s31 offen lds
    s_add_u32 s65, s65, 196608
    s_cmp_eq_u32 s67, 1024
    s_cselect_b32 s31, 1572864, 0
    s_cselect_b32 s67, 0, s67
    s_sub_u32 s65, s65, s31
    s_add_u32 s68, s68, 36864
    s_cmp_eq_u32 s68, 147456
    s_cselect_b32 s68, 0, s68
    s_waitcnt vmcnt(18)
    s_barrier
    s_waitcnt vmcnt(9)
    s_barrier
    s_add_u32 m0, s68, s66
    s_add_u32 s31, s64, s67
    buffer_load_dwordx4 v5, s[48:51], s67 offen lds
    s_add_u32 m0, m0, 4096
    s_add_u32 s32, s31, 32768
    buffer_load_dwordx4 v4, s[48:51], s31 offen lds
    s_add_u32 m0, m0, 4096
    s_add_u32 s67, s67, 128
    buffer_load_dwordx4 v4, s[48:51], s32 offen lds
    s_add_u32 m0, m0, 4096
    s_add_u32 s31, s65, 0
    buffer_load_dwordx4 v6, s[52:55], s31 offen lds
    s_add_u32 m0, m0, 4096
    s_add_u32 s31, s65, 98304
    buffer_load_dwordx4 v6, s[52:55], s31 offen lds
    s_add_u32 m0, m0, 4096
    s_add_u32 s31, s65, 1024
    buffer_load_dwordx4 v6, s[52:55], s31 offen lds
    s_add_u32 m0, m0, 4096
    s_add_u32 s31, s65, 99328
    buffer_load_dwordx4 v6, s[52:55], s31 offen lds
    s_add_u32 m0, m0, 4096
    s_add_u32 s31, s65, 2048
    buffer_load_dwordx4 v6, s[52:55], s31 offen lds
    s_add_u32 m0, m0, 4096
    s_add_u32 s31, s65, 100352
    buffer_load_dwordx4 v6, s[52:55], s31 offen lds
    s_add_u32 s65, s65, 196608
    s_cmp_eq_u32 s67, 1024
    s_cselect_b32 s31, 1572864, 0
    s_cselect_b32 s67, 0, s67
    s_sub_u32 s65, s65, s31
    s_add_u32 s68, s68, 36864
    s_cmp_eq_u32 s68, 147456
    s_cselect_b32 s68, 0, s68
    s_waitcnt vmcnt(9)
    s_barrier
    s_add_u32 m0, s68, s66
    s_add_u32 s31, s64, s67
    buffer_load_dwordx4 v5, s[48:51], s67 offen lds
    s_add_u32 m0, m0, 4096
    s_add_u32 s32, s31, 32768
    buffer_load_dwordx4 v4, s[48:51], s31 offen lds
    s_add_u32 m0, m0, 4096
    s_add_u32 s67, s67, 128
    buffer_load_dwordx4 v4, s[48:51], s32 offen lds
    s_add_u32 m0, m0, 4096
    s_add_u32 s31, s65, 0
    buffer_load_dwordx4 v6, s[52:55], s31 offen lds
    s_add_u32 m0, m0, 4096
    s_add_u32 s31, s65, 98304
    buffer_load_dwordx4 v6, s[52:55], s31 offen lds
    s_add_u32 m0, m0, 4096
    s_add_u32 s31, s65, 1024
    buffer_load_dwordx4 v6, s[52:55], s31 offen lds
    s_add_u32 m0, m0, 4096
    s_add_u32 s31, s65, 99328
    buffer_load_dwordx4 v6, s[52:55], s31 offen lds
    s_add_u32 m0, m0, 4096
    s_add_u32 s31, s65, 2048
    buffer_load_dwordx4 v6, s[52:55], s31 offen lds
    s_add_u32 m0, m0, 4096
    s_add_u32 s31, s65, 100352
    buffer_load_dwordx4 v6, s[52:55], s31 offen lds
    s_add_u32 s65, s65, 196608
    s_cmp_eq_u32 s67, 1024
    s_cselect_b32 s31, 1572864, 0
    s_cselect_b32 s67, 0, s67
    s_sub_u32 s65, s65, s31
    s_add_u32 s68, s68, 36864
    s_cmp_eq_u32 s68, 147456
    s_cselect_b32 s68, 0, s68
    s_waitcnt vmcnt(9)
    s_barrier
    v_mov_b32 v2, 147456
    ds_read_b32 v2, v2
    s_waitcnt lgkmcnt(0)
    v_readfirstlane_b32 s40, v2
    s_waitcnt vmcnt(0)
    s_barrier
    s_mov_b32 s72, s48
    s_mov_b32 s76, s52
    s_mov_b32 s73, s49
    s_mov_b32 s77, s53
    s_mov_b32 s74, s50
    s_mov_b32 s78, s54
    s_mov_b32 s75, s51
    s_mov_b32 s79, s55
    s_mov_b32 s48, s12
    s_and_b32 s49, s13, 0xffff
    s_mov_b32 s50, 0x700000
    s_mov_b32 s51, 0x20000
    s_mov_b32 s52, s26
    s_and_b32 s53, s27, 0xffff
    s_mov_b32 s54, 0x200000
    s_mov_b32 s55, 0x20000
    v_bfe_u32 v2, v1, 4, 1
    v_lshlrev_b32 v2, 2, v2
    v_and_b32 v8, 7, v1
    v_xor_b32 v8, v8, v2
    v_lshlrev_b32 v8, 4, v8
    v_lshrrev_b32 v2, 3, v1
    s_mov_b32 s31, 3584
    v_mul_lo_u32 v2, v2, s31
    v_add_u32 v8, v8, v2
    v_bfe_u32 v2, v1, 4, 1
    v_lshlrev_b32 v2, 2, v2
    v_and_b32 v9, 7, v1
    v_xor_b32 v9, v9, v2
    v_lshlrev_b32 v9, 4, v9
    v_lshrrev_b32 v2, 3, v1
    s_mov_b32 s31, 1024
    v_mul_lo_u32 v2, v2, s31
    v_add_u32 v9, v9, v2
    v_bfe_u32 v2, v1, 4, 1
    v_lshlrev_b32 v2, 2, v2
    v_and_b32 v10, 7, v1
    v_xor_b32 v10, v10, v2
    v_lshlrev_b32 v10, 4, v10
    v_lshrrev_b32 v2, 3, v1
    s_mov_b32 s31, 4096
    v_mul_lo_u32 v2, v2, s31
    v_add_u32 v10, v10, v2
    v_lshrrev_b32 v2, 3, v1
    v_lshl_add_u32 v12, v2, 10, v7
    s_movk_i32 s31, 3584
    v_mul_lo_u32 v2, v2, s31
    v_add_u32 v11, v7, v2
    s_cmp_ge_u32 s38, 28
    s_cbranch_scc1 L_NOP2
    v_mov_b32 v20, 147472
    s_mov_b32 s32, 0
    s_cmp_lg_u32 s29, 0
    s_cbranch_scc1 L_PH_W
    v_lshlrev_b32 v20, 4, v1
    s_and_b32 s31, s2, 7
    s_lshl_b32 s31, s31, 10
L_PH:
    buffer_load_dwordx4 v[16:19], v20, s[44:47], s31 offen sc1
    s_waitcnt vmcnt(0)
    v_xor_b32 v16, s40, v16
    v_xor_b32 v17, s40, v17
    v_or_b32 v16, v16, v17
    v_xor_b32 v18, s40, v18
    v_or_b32 v16, v16, v18
    v_xor_b32 v19, s40, v19
    v_or_b32 v16, v16, v19
    v_cmp_ne_u32 vcc, 0, v16
    s_add_u32 s32, s32, 1
    s_cmp_ge_u32 s32, 0x4000
    s_cbranch_scc1 L_PH_OK
    s_cmp_eq_u32 vcc_lo, 0
    s_cbranch_scc1 L_PH_OK
    s_sleep 8
    s_branch L_PH
L_PH_OK:
    v_mov_b32 v20, 147472
    v_mov_b32 v16, s40
    ds_write_b32 v20, v16
    s_waitcnt lgkmcnt(0)
    s_branch L_PH_X
L_PH_W:
    ds_read_b32 v16, v20
    s_waitcnt lgkmcnt(0)
    v_readfirstlane_b32 s31, v16
    s_add_u32 s32, s32, 1
    s_cmp_ge_u32 s32, 0x40000
    s_cbranch_scc1 L_PH_X
    s_cmp_eq_u32 s31, s40
    s_cbranch_scc1 L_PH_X
    s_sleep 1
    s_branch L_PH_W
L_PH_X:
    s_waitcnt vmcnt(0)
    s_mul_i32 s81, s29, 28672
    s_lshl_b32 s31, s36, 7
    s_add_u32 s81, s81, s31
    s_lshl_b32 s82, s29, 13
    s_lshl_b32 s31, s35, 7
    s_add_u32 s82, s82, s31
    s_mov_b32 s85, 0
    s_mov_b32 s68, 49152
    s_mov_b32 s83, 0
    s_add_u32 m0, s68, s66
    s_add_u32 s31, s81, 114688
    buffer_load_dwordx4 v8, s[48:51], s81 offen lds
    s_add_u32 m0, m0, 4096
    s_add_u32 s32, s82, 32768
    buffer_load_dwordx4 v8, s[48:51], s31 offen lds
    s_add_u32 m0, m0, 4096
    s_add_u32 s81, s81, 229376
    buffer_load_dwordx4 v9, s[52:55], s82 offen lds
    s_add_u32 m0, m0, 4096
    s_add_u32 s82, s82, 65536
    buffer_load_dwordx4 v9, s[52:55], s32 offen lds
    s_add_u32 s85, s85, 1
    s_cmp_eq_u32 s85, 32
    s_cselect_b32 s31, 7340032, 0
    s_cselect_b32 s32, 2097152, 0
    s_cselect_b32 s85, 0, s85
    s_sub_u32 s81, s81, s31
    s_sub_u32 s82, s82, s32
    s_add_u32 s68, s68, 16384
    s_cmp_eq_u32 s68, 147456
    s_cselect_b32 s68, 0, s68
    s_add_u32 s83, s83, 1
    s_add_u32 m0, s68, s66
    s_add_u32 s31, s81, 114688
    buffer_load_dwordx4 v8, s[48:51], s81 offen lds
    s_add_u32 m0, m0, 4096
    s_add_u32 s32, s82, 32768
    buffer_load_dwordx4 v8, s[48:51], s31 offen lds
    s_add_u32 m0, m0, 4096
    s_add_u32 s81, s81, 229376
    buffer_load_dwordx4 v9, s[52:55], s82 offen lds
    s_add_u32 m0, m0, 4096
    s_add_u32 s82, s82, 65536
    buffer_load_dwordx4 v9, s[52:55], s32 offen lds
    s_add_u32 s85, s85, 1
    s_cmp_eq_u32 s85, 32
    s_cselect_b32 s31, 7340032, 0
    s_cselect_b32 s32, 2097152, 0
    s_cselect_b32 s85, 0, s85
    s_sub_u32 s81, s81, s31
    s_sub_u32 s82, s82, s32
    s_add_u32 s68, s68, 16384
    s_cmp_eq_u32 s68, 147456
    s_cselect_b32 s68, 0, s68
    s_add_u32 s83, s83, 1
    s_add_u32 m0, s68, s66
    s_add_u32 s31, s81, 114688
    buffer_load_dwordx4 v8, s[48:51], s81 offen lds
    s_add_u32 m0, m0, 4096
    s_add_u32 s32, s82, 32768
    buffer_load_dwordx4 v8, s[48:51], s31 offen lds
    s_add_u32 m0, m0, 4096
    s_add_u32 s81, s81, 229376
    buffer_load_dwordx4 v9, s[52:55], s82 offen lds
    s_add_u32 m0, m0, 4096
    s_add_u32 s82, s82, 65536
    buffer_load_dwordx4 v9, s[52:55], s32 offen lds
    s_add_u32 s85, s85, 1
    s_cmp_eq_u32 s85, 32
    s_cselect_b32 s31, 7340032, 0
    s_cselect_b32 s32, 2097152, 0
    s_cselect_b32 s85, 0, s85
    s_sub_u32 s81, s81, s31
    s_sub_u32 s82, s82, s32
    s_add_u32 s68, s68, 16384
    s_cmp_eq_u32 s68, 147456
    s_cselect_b32 s68, 0, s68
    s_add_u32 s83, s83, 1
    s_waitcnt vmcnt(8)
    s_barrier
    s_add_u32 m0, s68, s66
    s_add_u32 s31, s81, 114688
    buffer_load_dwordx4 v8, s[48:51], s81 offen lds
    s_add_u32 m0, m0, 4096
    s_add_u32 s32, s82, 32768
    buffer_load_dwordx4 v8, s[48:51], s31 offen lds
    s_add_u32 m0, m0, 4096
    s_add_u32 s81, s81, 229376
    buffer_load_dwordx4 v9, s[52:55], s82 offen lds
    s_add_u32 m0, m0, 4096
    s_add_u32 s82, s82, 65536
    buffer_load_dwordx4 v9, s[52:55], s32 offen lds
    s_add_u32 s85, s85, 1
    s_cmp_eq_u32 s85, 32
    s_cselect_b32 s31, 7340032, 0
    s_cselect_b32 s32, 2097152, 0
    s_cselect_b32 s85, 0, s85
    s_sub_u32 s81, s81, s31
    s_sub_u32 s82, s82, s32
    s_add_u32 s68, s68, 16384
    s_cmp_eq_u32 s68, 147456
    s_cselect_b32 s68, 0, s68
    s_add_u32 s83, s83, 1
    s_add_u32 m0, s68, s66
    s_add_u32 s31, s81, 114688
    buffer_load_dwordx4 v8, s[48:51], s81 offen lds
    s_add_u32 m0, m0, 4096
    s_add_u32 s32, s82, 32768
    buffer_load_dwordx4 v8, s[48:51], s31 offen lds
    s_add_u32 m0, m0, 4096
    s_add_u32 s81, s81, 229376
    buffer_load_dwordx4 v9, s[52:55], s82 offen lds
    s_add_u32 m0, m0, 4096
    s_add_u32 s82, s82, 65536
    buffer_load_dwordx4 v9, s[52:55], s32 offen lds
    s_add_u32 s85, s85, 1
    s_cmp_eq_u32 s85, 32
    s_cselect_b32 s31, 7340032, 0
    s_cselect_b32 s32, 2097152, 0
    s_cselect_b32 s85, 0, s85
    s_sub_u32 s81, s81, s31
    s_sub_u32 s82, s82, s32
    s_add_u32 s68, s68, 16384
    s_cmp_eq_u32 s68, 147456
    s_cselect_b32 s68, 0, s68
    s_add_u32 s83, s83, 1
    s_waitcnt vmcnt(12)
    s_barrier
    s_add_u32 m0, s68, s66
    s_add_u32 s31, s81, 114688
    buffer_load_dwordx4 v8, s[48:51], s81 offen lds
    s_add_u32 m0, m0, 4096
    s_add_u32 s32, s82, 32768
    buffer_load_dwordx4 v8, s[48:51], s31 offen lds
    s_add_u32 m0, m0, 4096
    s_add_u32 s81, s81, 229376
    buffer_load_dwordx4 v9, s[52:55], s82 offen lds
    s_add_u32 m0, m0, 4096
    s_add_u32 s82, s82, 65536
    buffer_load_dwordx4 v9, s[52:55], s32 offen lds
    s_add_u32 s85, s85, 1
    s_cmp_eq_u32 s85, 32
    s_cselect_b32 s31, 7340032, 0
    s_cselect_b32 s32, 2097152, 0
    s_cselect_b32 s85, 0, s85
    s_sub_u32 s81, s81, s31
    s_sub_u32 s82, s82, s32
    s_add_u32 s68, s68, 16384
    s_cmp_eq_u32 s68, 147456
    s_cselect_b32 s68, 0, s68
    s_add_u32 s83, s83, 1
    s_add_u32 m0, s68, s66
    s_add_u32 s31, s81, 114688
    buffer_load_dwordx4 v8, s[48:51], s81 offen lds
    s_add_u32 m0, m0, 4096
    s_add_u32 s32, s82, 32768
    buffer_load_dwordx4 v8, s[48:51], s31 offen lds
    s_add_u32 m0, m0, 4096
    s_add_u32 s81, s81, 229376
    buffer_load_dwordx4 v9, s[52:55], s82 offen lds
    s_add_u32 m0, m0, 4096
    s_add_u32 s82, s82, 65536
    buffer_load_dwordx4 v9, s[52:55], s32 offen lds
    s_add_u32 s85, s85, 1
    s_cmp_eq_u32 s85, 32
    s_cselect_b32 s31, 7340032, 0
    s_cselect_b32 s32, 2097152, 0
    s_cselect_b32 s85, 0, s85
    s_sub_u32 s81, s81, s31
    s_sub_u32 s82, s82, s32
    s_add_u32 s68, s68, 16384
    s_cmp_eq_u32 s68, 147456
    s_cselect_b32 s68, 0, s68
    s_add_u32 s83, s83, 1
    s_waitcnt vmcnt(16)
    s_barrier
    s_add_u32 m0, s68, s66
    s_add_u32 s31, s81, 114688
    buffer_load_dwordx4 v8, s[48:51], s81 offen lds
    s_add_u32 m0, m0, 4096
    s_add_u32 s32, s82, 32768
    buffer_load_dwordx4 v8, s[48:51], s31 offen lds
    s_add_u32 m0, m0, 4096
    s_add_u32 s81, s81, 229376
    buffer_load_dwordx4 v9, s[52:55], s82 offen lds
    s_add_u32 m0, m0, 4096
    s_add_u32 s82, s82, 65536
    buffer_load_dwordx4 v9, s[52:55], s32 offen lds
    s_add_u32 s85, s85, 1
    s_cmp_eq_u32 s85, 32
    s_cselect_b32 s31, 7340032, 0
    s_cselect_b32 s32, 2097152, 0
    s_cselect_b32 s85, 0, s85
    s_sub_u32 s81, s81, s31
    s_sub_u32 s82, s82, s32
    s_add_u32 s68, s68, 16384
    s_cmp_eq_u32 s68, 147456
    s_cselect_b32 s68, 0, s68
    s_add_u32 s83, s83, 1
    s_add_u32 m0, s68, s66
    s_add_u32 s31, s81, 114688
    buffer_load_dwordx4 v8, s[48:51], s81 offen lds
    s_add_u32 m0, m0, 4096
    s_add_u32 s32, s82, 32768
    buffer_load_dwordx4 v8, s[48:51], s31 offen lds
    s_add_u32 m0, m0, 4096
    s_add_u32 s81, s81, 229376
    buffer_load_dwordx4 v9, s[52:55], s82 offen lds
    s_add_u32 m0, m0, 4096
    s_add_u32 s82, s82, 65536
    buffer_load_dwordx4 v9, s[52:55], s32 offen lds
    s_add_u32 s85, s85, 1
    s_cmp_eq_u32 s85, 32
    s_cselect_b32 s31, 7340032, 0
    s_cselect_b32 s32, 2097152, 0
    s_cselect_b32 s85, 0, s85
    s_sub_u32 s81, s81, s31
    s_sub_u32 s82, s82, s32
    s_add_u32 s68, s68, 16384
    s_cmp_eq_u32 s68, 147456
    s_cselect_b32 s68, 0, s68
    s_add_u32 s83, s83, 1
    s_waitcnt vmcnt(20)
    s_barrier
    s_add_u32 m0, s68, s66
    s_add_u32 s31, s81, 114688
    buffer_load_dwordx4 v8, s[48:51], s81 offen lds
    s_add_u32 m0, m0, 4096
    s_add_u32 s32, s82, 32768
    buffer_load_dwordx4 v8, s[48:51], s31 offen lds
    s_add_u32 m0, m0, 4096
    s_add_u32 s81, s81, 229376
    buffer_load_dwordx4 v9, s[52:55], s82 offen lds
    s_add_u32 m0, m0, 4096
    s_add_u32 s82, s82, 65536
    buffer_load_dwordx4 v9, s[52:55], s32 offen lds
    s_add_u32 s85, s85, 1
    s_cmp_eq_u32 s85, 32
    s_cselect_b32 s31, 7340032, 0
    s_cselect_b32 s32, 2097152, 0
    s_cselect_b32 s85, 0, s85
    s_sub_u32 s81, s81, s31
    s_sub_u32 s82, s82, s32
    s_add_u32 s68, s68, 16384
    s_cmp_eq_u32 s68, 147456
    s_cselect_b32 s68, 0, s68
    s_add_u32 s83, s83, 1
    s_add_u32 m0, s68, s66
    s_add_u32 s31, s81, 114688
    buffer_load_dwordx4 v8, s[48:51], s81 offen lds
    s_add_u32 m0, m0, 4096
    s_add_u32 s32, s82, 32768
    buffer_load_dwordx4 v8, s[48:51], s31 offen lds
    s_add_u32 m0, m0, 4096
    s_add_u32 s81, s81, 229376
    buffer_load_dwordx4 v9, s[52:55], s82 offen lds
    s_add_u32 m0, m0, 4096
    s_add_u32 s82, s82, 65536
    buffer_load_dwordx4 v9, s[52:55], s32 offen lds
    s_add_u32 s85, s85, 1
    s_cmp_eq_u32 s85, 32
    s_cselect_b32 s31, 7340032, 0
    s_cselect_b32 s32, 2097152, 0
    s_cselect_b32 s85, 0, s85
    s_sub_u32 s81, s81, s31
    s_sub_u32 s82, s82, s32
    s_add_u32 s68, s68, 16384
    s_cmp_eq_u32 s68, 147456
    s_cselect_b32 s68, 0, s68
    s_add_u32 s83, s83, 1
L_P2a:
    s_waitcnt vmcnt(24)
    s_barrier
    s_add_u32 m0, s68, s66
    s_add_u32 s31, s81, 114688
    buffer_load_dwordx4 v8, s[48:51], s81 offen lds
    s_add_u32 m0, m0, 4096
    s_add_u32 s32, s82, 32768
    buffer_load_dwordx4 v8, s[48:51], s31 offen lds
    s_add_u32 m0, m0, 4096
    s_add_u32 s81, s81, 229376
    buffer_load_dwordx4 v9, s[52:55], s82 offen lds
    s_add_u32 m0, m0, 4096
    s_add_u32 s82, s82, 65536
    buffer_load_dwordx4 v9, s[52:55], s32 offen lds
    s_add_u32 s85, s85, 1
    s_cmp_eq_u32 s85, 32
    s_cselect_b32 s31, 7340032, 0
    s_cselect_b32 s32, 2097152, 0
    s_cselect_b32 s85, 0, s85
    s_sub_u32 s81, s81, s31
    s_sub_u32 s82, s82, s32
    s_add_u32 s68, s68, 16384
    s_cmp_eq_u32 s68, 147456
    s_cselect_b32 s68, 0, s68
    s_add_u32 s83, s83, 1
    s_cmp_lt_u32 s83, 16
    s_cbranch_scc1 L_P2a
    v_mov_b32 v20, 147484
    s_mov_b32 s32, 0
L_PH2:
    ds_read_b32 v16, v20
    s_waitcnt lgkmcnt(0)
    v_readfirstlane_b32 s31, v16
    s_add_u32 s32, s32, 1
    s_cmp_ge_u32 s32, 0x40000
    s_cbranch_scc1 L_PH2_X
    s_cmp_eq_u32 s31, s40
    s_cbranch_scc1 L_PH2_X
    s_sleep 1
    s_branch L_PH2
L_PH2_X:
L_P2:
    s_waitcnt vmcnt(24)
    s_barrier
    s_add_u32 m0, s68, s66
    s_add_u32 s31, s81, 114688
    buffer_load_dwordx4 v8, s[48:51], s81 offen lds
    s_add_u32 m0, m0, 4096
    s_add_u32 s32, s82, 32768
    buffer_load_dwordx4 v8, s[48:51], s31 offen lds
    s_add_u32 m0, m0, 4096
    s_add_u32 s81, s81, 229376
    buffer_load_dwordx4 v9, s[52:55], s82 offen lds
    s_add_u32 m0, m0, 4096
    s_add_u32 s82, s82, 65536
    buffer_load_dwordx4 v9, s[52:55], s32 offen lds
    s_add_u32 s85, s85, 1
    s_cmp_eq_u32 s85, 32
    s_cselect_b32 s31, 7340032, 0
    s_cselect_b32 s32, 2097152, 0
    s_cselect_b32 s85, 0, s85
    s_sub_u32 s81, s81, s31
    s_sub_u32 s82, s82, s32
    s_add_u32 s68, s68, 16384
    s_cmp_eq_u32 s68, 147456
    s_cselect_b32 s68, 0, s68
    s_add_u32 s83, s83, 1
    s_cmp_lt_u32 s83, 32
    s_cbranch_scc1 L_P2
    s_mov_b32 s80, 0
    s_waitcnt vmcnt(24)
    s_barrier
    s_waitcnt vmcnt(20)
    s_barrier
    s_waitcnt vmcnt(16)
    s_barrier
    s_waitcnt vmcnt(12)
    s_barrier
    s_add_u32 m0, s80, s66
    s_add_u32 s31, s64, s67
    buffer_load_dwordx4 v5, s[72:75], s67 offen lds
    s_add_u32 m0, m0, 4096
    s_add_u32 s32, s31, 32768
    buffer_load_dwordx4 v4, s[72:75], s31 offen lds
    s_add_u32 m0, m0, 4096
    s_add_u32 s67, s67, 128
    buffer_load_dwordx4 v4, s[72:75], s32 offen lds
    s_add_u32 m0, m0, 4096
    s_add_u32 s31, s65, 0
    buffer_load_dwordx4 v6, s[76:79], s31 offen lds
    s_add_u32 m0, m0, 4096
    s_add_u32 s31, s65, 98304
    buffer_load_dwordx4 v6, s[76:79], s31 offen lds
    s_add_u32 m0, m0, 4096
    s_add_u32 s31, s65, 1024
    buffer_load_dwordx4 v6, s[76:79], s31 offen lds
    s_add_u32 m0, m0, 4096
    s_add_u32 s31, s65, 99328
    buffer_load_dwordx4 v6, s[76:79], s31 offen lds
    s_add_u32 m0, m0, 4096
    s_add_u32 s31, s65, 2048
    buffer_load_dwordx4 v6, s[76:79], s31 offen lds
    s_add_u32 m0, m0, 4096
    s_add_u32 s31, s65, 100352
    buffer_load_dwordx4 v6, s[76:79], s31 offen lds
    s_add_u32 s65, s65, 196608
    s_cmp_eq_u32 s67, 1024
    s_cselect_b32 s31, 1572864, 0
    s_cselect_b32 s67, 0, s67
    s_sub_u32 s65, s65, s31
    s_add_u32 s80, s80, 36864
    s_cmp_eq_u32 s80, 147456
    s_cselect_b32 s80, 0, s80
    s_waitcnt vmcnt(17)
    s_barrier
    s_waitcnt vmcnt(13)
    s_barrier
    s_add_u32 m0, s80, s66
    s_add_u32 s31, s64, s67
    buffer_load_dwordx4 v5, s[72:75], s67 offen lds
    s_add_u32 m0, m0, 4096
    s_add_u32 s32, s31, 32768
    buffer_load_dwordx4 v4, s[72:75], s31 offen lds
    s_add_u32 m0, m0, 4096
    s_add_u32 s67, s67, 128
    buffer_load_dwordx4 v4, s[72:75], s32 offen lds
    s_add_u32 m0, m0, 4096
    s_add_u32 s31, s65, 0
    buffer_load_dwordx4 v6, s[76:79], s31 offen lds
    s_add_u32 m0, m0, 4096
    s_add_u32 s31, s65, 98304
    buffer_load_dwordx4 v6, s[76:79], s31 offen lds
    s_add_u32 m0, m0, 4096
    s_add_u32 s31, s65, 1024
    buffer_load_dwordx4 v6, s[76:79], s31 offen lds
    s_add_u32 m0, m0, 4096
    s_add_u32 s31, s65, 99328
    buffer_load_dwordx4 v6, s[76:79], s31 offen lds
    s_add_u32 m0, m0, 4096
    s_add_u32 s31, s65, 2048
    buffer_load_dwordx4 v6, s[76:79], s31 offen lds
    s_add_u32 m0, m0, 4096
    s_add_u32 s31, s65, 100352
    buffer_load_dwordx4 v6, s[76:79], s31 offen lds
    s_add_u32 s65, s65, 196608
    s_cmp_eq_u32 s67, 1024
    s_cselect_b32 s31, 1572864, 0
    s_cselect_b32 s67, 0, s67
    s_sub_u32 s65, s65, s31
    s_add_u32 s80, s80, 36864
    s_cmp_eq_u32 s80, 147456
    s_cselect_b32 s80, 0, s80
    s_waitcnt vmcnt(18)
    s_barrier
    s_barrier
    s_add_u32 m0, s80, s66
    s_add_u32 s31, s64, s67
    buffer_load_dwordx4 v5, s[72:75], s67 offen lds
    s_add_u32 m0, m0, 4096
    s_add_u32 s32, s31, 32768
    buffer_load_dwordx4 v4, s[72:75], s31 offen lds
    s_add_u32 m0, m0, 4096
    s_add_u32 s67, s67, 128
    buffer_load_dwordx4 v4, s[72:75], s32 offen lds
    s_add_u32 m0, m0, 4096
    s_add_u32 s31, s65, 0
    buffer_load_dwordx4 v6, s[76:79], s31 offen lds
    s_add_u32 m0, m0, 4096
    s_add_u32 s31, s65, 98304
    buffer_load_dwordx4 v6, s[76:79], s31 offen lds
    s_add_u32 m0, m0, 4096
    s_add_u32 s31, s65, 1024
    buffer_load_dwordx4 v6, s[76:79], s31 offen lds
    s_add_u32 m0, m0, 4096
    s_add_u32 s31, s65, 99328
    buffer_load_dwordx4 v6, s[76:79], s31 offen lds
    s_add_u32 m0, m0, 4096
    s_add_u32 s31, s65, 2048
    buffer_load_dwordx4 v6, s[76:79], s31 offen lds
    s_add_u32 m0, m0, 4096
    s_add_u32 s31, s65, 100352
    buffer_load_dwordx4 v6, s[76:79], s31 offen lds
    s_add_u32 s65, s65, 196608
    s_cmp_eq_u32 s67, 1024
    s_cselect_b32 s31, 1572864, 0
    s_cselect_b32 s67, 0, s67
    s_sub_u32 s65, s65, s31
    s_add_u32 s80, s80, 36864
    s_cmp_eq_u32 s80, 147456
    s_cselect_b32 s80, 0, s80
    s_branch L_P1B
L_NOP2:
    s_mov_b32 s80, 0
    s_barrier
    s_add_u32 m0, s80, s66
    s_add_u32 s31, s64, s67
    buffer_load_dwordx4 v5, s[72:75], s67 offen lds
    s_add_u32 m0, m0, 4096
    s_add_u32 s32, s31, 32768
    buffer_load_dwordx4 v4, s[72:75], s31 offen lds
    s_add_u32 m0, m0, 4096
    s_add_u32 s67, s67, 128
    buffer_load_dwordx4 v4, s[72:75], s32 offen lds
    s_add_u32 m0, m0, 4096
    s_add_u32 s31, s65, 0
    buffer_load_dwordx4 v6, s[76:79], s31 offen lds
    s_add_u32 m0, m0, 4096
    s_add_u32 s31, s65, 98304
    buffer_load_dwordx4 v6, s[76:79], s31 offen lds
    s_add_u32 m0, m0, 4096
    s_add_u32 s31, s65, 1024
    buffer_load_dwordx4 v6, s[76:79], s31 offen lds
    s_add_u32 m0, m0, 4096
    s_add_u32 s31, s65, 99328
    buffer_load_dwordx4 v6, s[76:79], s31 offen lds
    s_add_u32 m0, m0, 4096
    s_add_u32 s31, s65, 2048
    buffer_load_dwordx4 v6, s[76:79], s31 offen lds
    s_add_u32 m0, m0, 4096
    s_add_u32 s31, s65, 100352
    buffer_load_dwordx4 v6, s[76:79], s31 offen lds
    s_add_u32 s65, s65, 196608
    s_cmp_eq_u32 s67, 1024
    s_cselect_b32 s31, 1572864, 0
    s_cselect_b32 s67, 0, s67
    s_sub_u32 s65, s65, s31
    s_add_u32 s80, s80, 36864
    s_cmp_eq_u32 s80, 147456
    s_cselect_b32 s80, 0, s80
    s_add_u32 m0, s80, s66
    s_add_u32 s31, s64, s67
    buffer_load_dwordx4 v5, s[72:75], s67 offen lds
    s_add_u32 m0, m0, 4096
    s_add_u32 s32, s31, 32768
    buffer_load_dwordx4 v4, s[72:75], s31 offen lds
    s_add_u32 m0, m0, 4096
    s_add_u32 s67, s67, 128
    buffer_load_dwordx4 v4, s[72:75], s32 offen lds
    s_add_u32 m0, m0, 4096
    s_add_u32 s31, s65, 0
    buffer_load_dwordx4 v6, s[76:79], s31 offen lds
    s_add_u32 m0, m0, 4096
    s_add_u32 s31, s65, 98304
    buffer_load_dwordx4 v6, s[76:79], s31 offen lds
    s_add_u32 m0, m0, 4096
    s_add_u32 s31, s65, 1024
    buffer_load_dwordx4 v6, s[76:79], s31 offen lds
    s_add_u32 m0, m0, 4096
    s_add_u32 s31, s65, 99328
    buffer_load_dwordx4 v6, s[76:79], s31 offen lds
    s_add_u32 m0, m0, 4096
    s_add_u32 s31, s65, 2048
    buffer_load_dwordx4 v6, s[76:79], s31 offen lds
    s_add_u32 m0, m0, 4096
    s_add_u32 s31, s65, 100352
    buffer_load_dwordx4 v6, s[76:79], s31 offen lds
    s_add_u32 s65, s65, 196608
    s_cmp_eq_u32 s67, 1024
    s_cselect_b32 s31, 1572864, 0
    s_cselect_b32 s67, 0, s67
    s_sub_u32 s65, s65, s31
    s_add_u32 s80, s80, 36864
    s_cmp_eq_u32 s80, 147456
    s_cselect_b32 s80, 0, s80
    s_add_u32 m0, s80, s66
    s_add_u32 s31, s64, s67
    buffer_load_dwordx4 v5, s[72:75], s67 offen lds
    s_add_u32 m0, m0, 4096
    s_add_u32 s32, s31, 32768
    buffer_load_dwordx4 v4, s[72:75], s31 offen lds
    s_add_u32 m0, m0, 4096
    s_add_u32 s67, s67, 128
    buffer_load_dwordx4 v4, s[72:75], s32 offen lds
    s_add_u32 m0, m0, 4096
    s_add_u32 s31, s65, 0
    buffer_load_dwordx4 v6, s[76:79], s31 offen lds
    s_add_u32 m0, m0, 4096
    s_add_u32 s31, s65, 98304
    buffer_load_dwordx4 v6, s[76:79], s31 offen lds
    s_add_u32 m0, m0, 4096
    s_add_u32 s31, s65, 1024
    buffer_load_dwordx4 v6, s[76:79], s31 offen lds
    s_add_u32 m0, m0, 4096
    s_add_u32 s31, s65, 99328
    buffer_load_dwordx4 v6, s[76:79], s31 offen lds
    s_add_u32 m0, m0, 4096
    s_add_u32 s31, s65, 2048
    buffer_load_dwordx4 v6, s[76:79], s31 offen lds
    s_add_u32 m0, m0, 4096
    s_add_u32 s31, s65, 100352
    buffer_load_dwordx4 v6, s[76:79], s31 offen lds
    s_add_u32 s65, s65, 196608
    s_cmp_eq_u32 s67, 1024
    s_cselect_b32 s31, 1572864, 0
    s_cselect_b32 s67, 0, s67
    s_sub_u32 s65, s65, s31
    s_add_u32 s80, s80, 36864
    s_cmp_eq_u32 s80, 147456
    s_cselect_b32 s80, 0, s80
L_P1B:
    s_waitcnt vmcnt(18)
    s_barrier
    s_waitcnt vmcnt(9)
    s_barrier
    s_waitcnt vmcnt(0)
    s_barrier
    s_barrier
    s_barrier
    s_add_u32 s56, s26, 0x400000
    s_addc_u32 s57, s27, 0
    s_and_b32 s57, s57, 0xffff
    s_mov_b32 s58, 0x1c0000
    s_mov_b32 s59, 0x20000
    s_mov_b32 s60, s16
    s_and_b32 s61, s17, 0xffff
    s_mov_b32 s62, 0x700000
    s_mov_b32 s63, 0x20000
    s_lshl_b32 s81, s35, 6
    s_lshl_b32 s31, s29, 3
    s_add_u32 s81, s81, s31
    s_mul_i32 s81, s81, 3584
    s_lshl_b32 s82, s29, 15
    s_lshl_b32 s31, s37, 7
    s_add_u32 s82, s82, s31
    s_mov_b32 s85, 0
    v_mov_b32 v20, 147480
    s_mov_b32 s32, 0
    s_cmp_lg_u32 s29, 0
    s_cbranch_scc1 L_PU_W
    v_lshlrev_b32 v20, 2, v1
    s_lshl_b32 s31, s2, 7
    s_add_u32 s31, s31, 8192
    v_and_b32 v20, 0x7f, v20
L_PU:
    buffer_load_dword v16, v20, s[44:47], s31 offen sc1
    s_waitcnt vmcnt(0)
    v_cmp_ne_u32 vcc, s40, v16
    s_add_u32 s32, s32, 1
    s_cmp_ge_u32 s32, 0x4000
    s_cbranch_scc1 L_PU_OK
    s_and_b32 vcc_lo, vcc_lo, 0x0fffffff
    s_cmp_eq_u32 vcc_lo, 0
    s_cbranch_scc1 L_PU_OK
    s_bcnt1_i32_b32 s84, vcc_lo
    s_cmp_lt_u32 s38, 28
    s_cselect_b32 s84, 0, s84
    s_cmp_gt_u32 s84, 24
    s_cbranch_scc1 L_PU_L
    s_sleep 3
    s_branch L_PU
L_PU_L:
    s_sleep 32
    s_branch L_PU
L_PU_OK:
    v_mov_b32 v20, 147480
    v_mov_b32 v16, s40
    ds_write_b32 v20, v16
    s_waitcnt lgkmcnt(0)
    s_branch L_PU_X
L_PU_W:
    ds_read_b32 v16, v20
    s_waitcnt lgkmcnt(0)
    v_readfirstlane_b32 s31, v16
    s_add_u32 s32, s32, 1
    s_cmp_ge_u32 s32, 0x40000
    s_cbranch_scc1 L_PU_X
    s_cmp_eq_u32 s31, s40
    s_cbranch_scc1 L_PU_X
    s_sleep 1
    s_branch L_PU_W
L_PU_X:
    s_waitcnt vmcnt(0)
    s_mov_b32 s68, 0
    s_mov_b32 s83, 0
    s_add_u32 m0, s68, s66
    s_add_u32 s31, s81, 114688
    buffer_load_dwordx4 v11, s[56:59], s81 offen lds
    s_add_u32 m0, m0, 4096
    s_add_u32 s32, s82, 131072
    buffer_load_dwordx4 v11, s[56:59], s31 offen lds
    s_add_u32 m0, m0, 4096
    s_add_u32 s81, s81, 128
    buffer_load_dwordx4 v10, s[60:63], s82 offen lds
    s_add_u32 m0, m0, 4096
    s_add_u32 s82, s82, 262144
    buffer_load_dwordx4 v10, s[60:63], s32 offen lds
    s_add_u32 s85, s85, 1
    s_cmp_eq_u32 s85, 28
    s_cselect_b32 s31, 3584, 0
    s_cselect_b32 s32, 7340032, 0
    s_cselect_b32 s85, 0, s85
    s_sub_u32 s81, s81, s31
    s_sub_u32 s82, s82, s32
    s_add_u32 s68, s68, 16384
    s_cmp_eq_u32 s68, 147456
    s_cselect_b32 s68, 0, s68
    s_add_u32 s83, s83, 1
    s_add_u32 m0, s68, s66
    s_add_u32 s31, s81, 114688
    buffer_load_dwordx4 v11, s[56:59], s81 offen lds
    s_add_u32 m0, m0, 4096
    s_add_u32 s32, s82, 131072
    buffer_load_dwordx4 v11, s[56:59], s31 offen lds
    s_add_u32 m0, m0, 4096
    s_add_u32 s81, s81, 128
    buffer_load_dwordx4 v10, s[60:63], s82 offen lds
    s_add_u32 m0, m0, 4096
    s_add_u32 s82, s82, 262144
    buffer_load_dwordx4 v10, s[60:63], s32 offen lds
    s_add_u32 s85, s85, 1
    s_cmp_eq_u32 s85, 28
    s_cselect_b32 s31, 3584, 0
    s_cselect_b32 s32, 7340032, 0
    s_cselect_b32 s85, 0, s85
    s_sub_u32 s81, s81, s31
    s_sub_u32 s82, s82, s32
    s_add_u32 s68, s68, 16384
    s_cmp_eq_u32 s68, 147456
    s_cselect_b32 s68, 0, s68
    s_add_u32 s83, s83, 1
    s_add_u32 m0, s68, s66
    s_add_u32 s31, s81, 114688
    buffer_load_dwordx4 v11, s[56:59], s81 offen lds
    s_add_u32 m0, m0, 4096
    s_add_u32 s32, s82, 131072
    buffer_load_dwordx4 v11, s[56:59], s31 offen lds
    s_add_u32 m0, m0, 4096
    s_add_u32 s81, s81, 128
    buffer_load_dwordx4 v10, s[60:63], s82 offen lds
    s_add_u32 m0, m0, 4096
    s_add_u32 s82, s82, 262144
    buffer_load_dwordx4 v10, s[60:63], s32 offen lds
    s_add_u32 s85, s85, 1
    s_cmp_eq_u32 s85, 28
    s_cselect_b32 s31, 3584, 0
    s_cselect_b32 s32, 7340032, 0
    s_cselect_b32 s85, 0, s85
    s_sub_u32 s81, s81, s31
    s_sub_u32 s82, s82, s32
    s_add_u32 s68, s68, 16384
    s_cmp_eq_u32 s68, 147456
    s_cselect_b32 s68, 0, s68
    s_add_u32 s83, s83, 1
    s_add_u32 m0, s68, s66
    s_add_u32 s31, s81, 114688
    buffer_load_dwordx4 v11, s[56:59], s81 offen lds
    s_add_u32 m0, m0, 4096
    s_add_u32 s32, s82, 131072
    buffer_load_dwordx4 v11, s[56:59], s31 offen lds
    s_add_u32 m0, m0, 4096
    s_add_u32 s81, s81, 128
    buffer_load_dwordx4 v10, s[60:63], s82 offen lds
    s_add_u32 m0, m0, 4096
    s_add_u32 s82, s82, 262144
    buffer_load_dwordx4 v10, s[60:63], s32 offen lds
    s_add_u32 s85, s85, 1
    s_cmp_eq_u32 s85, 28
    s_cselect_b32 s31, 3584, 0
    s_cselect_b32 s32, 7340032, 0
    s_cselect_b32 s85, 0, s85
    s_sub_u32 s81, s81, s31
    s_sub_u32 s82, s82, s32
    s_add_u32 s68, s68, 16384
    s_cmp_eq_u32 s68, 147456
    s_cselect_b32 s68, 0, s68
    s_add_u32 s83, s83, 1
    s_add_u32 m0, s68, s66
    s_add_u32 s31, s81, 114688
    buffer_load_dwordx4 v11, s[56:59], s81 offen lds
    s_add_u32 m0, m0, 4096
    s_add_u32 s32, s82, 131072
    buffer_load_dwordx4 v11, s[56:59], s31 offen lds
    s_add_u32 m0, m0, 4096
    s_add_u32 s81, s81, 128
    buffer_load_dwordx4 v10, s[60:63], s82 offen lds
    s_add_u32 m0, m0, 4096
    s_add_u32 s82, s82, 262144
    buffer_load_dwordx4 v10, s[60:63], s32 offen lds
    s_add_u32 s85, s85, 1
    s_cmp_eq_u32 s85, 28
    s_cselect_b32 s31, 3584, 0
    s_cselect_b32 s32, 7340032, 0
    s_cselect_b32 s85, 0, s85
    s_sub_u32 s81, s81, s31
    s_sub_u32 s82, s82, s32
    s_add_u32 s68, s68, 16384
    s_cmp_eq_u32 s68, 147456
    s_cselect_b32 s68, 0, s68
    s_add_u32 s83, s83, 1
    s_add_u32 m0, s68, s66
    s_add_u32 s31, s81, 114688
    buffer_load_dwordx4 v11, s[56:59], s81 offen lds
    s_add_u32 m0, m0, 4096
    s_add_u32 s32, s82, 131072
    buffer_load_dwordx4 v11, s[56:59], s31 offen lds
    s_add_u32 m0, m0, 4096
    s_add_u32 s81, s81, 128
    buffer_load_dwordx4 v10, s[60:63], s82 offen lds
    s_add_u32 m0, m0, 4096
    s_add_u32 s82, s82, 262144
    buffer_load_dwordx4 v10, s[60:63], s32 offen lds
    s_add_u32 s85, s85, 1
    s_cmp_eq_u32 s85, 28
    s_cselect_b32 s31, 3584, 0
    s_cselect_b32 s32, 7340032, 0
    s_cselect_b32 s85, 0, s85
    s_sub_u32 s81, s81, s31
    s_sub_u32 s82, s82, s32
    s_add_u32 s68, s68, 16384
    s_cmp_eq_u32 s68, 147456
    s_cselect_b32 s68, 0, s68
    s_add_u32 s83, s83, 1
    s_waitcnt vmcnt(20)
    s_barrier
    s_add_u32 m0, s68, s66
    s_add_u32 s31, s81, 114688
    buffer_load_dwordx4 v11, s[56:59], s81 offen lds
    s_add_u32 m0, m0, 4096
    s_add_u32 s32, s82, 131072
    buffer_load_dwordx4 v11, s[56:59], s31 offen lds
    s_add_u32 m0, m0, 4096
    s_add_u32 s81, s81, 128
    buffer_load_dwordx4 v10, s[60:63], s82 offen lds
    s_add_u32 m0, m0, 4096
    s_add_u32 s82, s82, 262144
    buffer_load_dwordx4 v10, s[60:63], s32 offen lds
    s_add_u32 s85, s85, 1
    s_cmp_eq_u32 s85, 28
    s_cselect_b32 s31, 3584, 0
    s_cselect_b32 s32, 7340032, 0
    s_cselect_b32 s85, 0, s85
    s_sub_u32 s81, s81, s31
    s_sub_u32 s82, s82, s32
    s_add_u32 s68, s68, 16384
    s_cmp_eq_u32 s68, 147456
    s_cselect_b32 s68, 0, s68
    s_add_u32 s83, s83, 1
    s_add_u32 m0, s68, s66
    s_add_u32 s31, s81, 114688
    buffer_load_dwordx4 v11, s[56:59], s81 offen lds
    s_add_u32 m0, m0, 4096
    s_add_u32 s32, s82, 131072
    buffer_load_dwordx4 v11, s[56:59], s31 offen lds
    s_add_u32 m0, m0, 4096
    s_add_u32 s81, s81, 128
    buffer_load_dwordx4 v10, s[60:63], s82 offen lds
    s_add_u32 m0, m0, 4096
    s_add_u32 s82, s82, 262144
    buffer_load_dwordx4 v10, s[60:63], s32 offen lds
    s_add_u32 s85, s85, 1
    s_cmp_eq_u32 s85, 28
    s_cselect_b32 s31, 3584, 0
    s_cselect_b32 s32, 7340032, 0
    s_cselect_b32 s85, 0, s85
    s_sub_u32 s81, s81, s31
    s_sub_u32 s82, s82, s32
    s_add_u32 s68, s68, 16384
    s_cmp_eq_u32 s68, 147456
    s_cselect_b32 s68, 0, s68
    s_add_u32 s83, s83, 1
L_PB:
    s_waitcnt vmcnt(24)
    s_barrier
    s_add_u32 m0, s68, s66
    s_add_u32 s31, s81, 114688
    buffer_load_dwordx4 v11, s[56:59], s81 offen lds
    s_add_u32 m0, m0, 4096
    s_add_u32 s32, s82, 131072
    buffer_load_dwordx4 v11, s[56:59], s31 offen lds
    s_add_u32 m0, m0, 4096
    s_add_u32 s81, s81, 128
    buffer_load_dwordx4 v10, s[60:63], s82 offen lds
    s_add_u32 m0, m0, 4096
    s_add_u32 s82, s82, 262144
    buffer_load_dwordx4 v10, s[60:63], s32 offen lds
    s_add_u32 s85, s85, 1
    s_cmp_eq_u32 s85, 28
    s_cselect_b32 s31, 3584, 0
    s_cselect_b32 s32, 7340032, 0
    s_cselect_b32 s85, 0, s85
    s_sub_u32 s81, s81, s31
    s_sub_u32 s82, s82, s32
    s_add_u32 s68, s68, 16384
    s_cmp_eq_u32 s68, 147456
    s_cselect_b32 s68, 0, s68
    s_add_u32 s83, s83, 1
    s_cmp_lt_u32 s83, 28
    s_cbranch_scc1 L_PB
    v_mov_b32 v20, 147476
    s_mov_b32 s32, 0
L_PO:
    ds_read_b32 v16, v20
    s_waitcnt lgkmcnt(0)
    v_readfirstlane_b32 s31, v16
    s_add_u32 s32, s32, 1
    s_cmp_ge_u32 s32, 0x40000
    s_cbranch_scc1 L_PO_X
    s_cmp_eq_u32 s31, s40
    s_cbranch_scc1 L_PO_X
    s_sleep 1
    s_branch L_PO
L_PO_X:
    s_mov_b32 s48, s8
    s_and_b32 s49, s9, 0xffff
    s_mov_b32 s50, 0x80000
    s_mov_b32 s51, 0x20000
    s_add_u32 s52, s26, 0x200000
    s_addc_u32 s53, s27, 0
    s_and_b32 s53, s53, 0xffff
    s_mov_b32 s54, 0x200000
    s_mov_b32 s55, 0x20000
    s_lshl_b32 s81, s29, 13
    s_lshl_b32 s31, s35, 7
    s_add_u32 s81, s81, s31
    s_lshl_b32 s82, s37, 6
    s_lshl_b32 s31, s29, 3
    s_add_u32 s82, s82, s31
    s_lshl_b32 s82, s82, 10
    s_mov_b32 s85, 0
L_PA:
    s_waitcnt vmcnt(24)
    s_barrier
    s_add_u32 m0, s68, s66
    s_add_u32 s31, s81, 32768
    buffer_load_dwordx4 v9, s[48:51], s81 offen lds
    s_add_u32 m0, m0, 4096
    s_add_u32 s32, s82, 32768
    buffer_load_dwordx4 v9, s[48:51], s31 offen lds
    s_add_u32 m0, m0, 4096
    s_add_u32 s81, s81, 65536
    buffer_load_dwordx4 v12, s[52:55], s82 offen lds
    s_add_u32 m0, m0, 4096
    s_add_u32 s82, s82, 128
    buffer_load_dwordx4 v12, s[52:55], s32 offen lds
    s_add_u32 s85, s85, 1
    s_cmp_eq_u32 s85, 8
    s_cselect_b32 s31, 524288, 0
    s_cselect_b32 s32, 1024, 0
    s_cselect_b32 s85, 0, s85
    s_sub_u32 s81, s81, s31
    s_sub_u32 s82, s82, s32
    s_add_u32 s68, s68, 16384
    s_cmp_eq_u32 s68, 147456
    s_cselect_b32 s68, 0, s68
    s_add_u32 s83, s83, 1
    s_cmp_lt_u32 s83, 36
    s_cbranch_scc1 L_PA
    s_waitcnt vmcnt(24)
    s_barrier
    s_waitcnt vmcnt(20)
    s_barrier
    s_waitcnt vmcnt(16)
    s_barrier
    s_waitcnt vmcnt(12)
    s_barrier
    s_waitcnt vmcnt(8)
    s_barrier
    s_waitcnt vmcnt(4)
    s_barrier
    s_waitcnt vmcnt(0)
    s_barrier
    s_endpgm
F_CONS:
    s_mov_b32 s48, s4
    s_and_b32 s49, s5, 0xffff
    s_mov_b32 s50, 0x200000
    s_mov_b32 s51, 0x20000
    s_mov_b32 s64, s20
    s_and_b32 s65, s21, 0xffff
    s_mov_b32 s66, 0x400
    s_mov_b32 s67, 0x20000
    s_mov_b32 s52, s26
    s_and_b32 s53, s27, 0xffff
    s_mov_b32 s54, 0x200000
    s_mov_b32 s55, 0x20000
    s_add_u32 s56, s26, 0x200000
    s_addc_u32 s57, s27, 0
    s_and_b32 s57, s57, 0xffff
    s_mov_b32 s58, 0x200000
    s_mov_b32 s59, 0x20000
    s_add_u32 s60, s26, 0x600000
    s_addc_u32 s61, s27, 0
    s_and_b32 s61, s61, 0xffff
    s_mov_b32 s62, 0x2000
    s_mov_b32 s63, 0x20000
    s_mov_b32 s68, s24
    s_and_b32 s69, s25, 0xffff
    s_mov_b32 s70, 0x100
    s_mov_b32 s71, 0x20000
    s_lshl_b32 s74, s2, 3
    s_lshl_b32 s31, s29, 1
    s_add_u32 s74, s74, s31
    s_lshl_b32 s75, s74, 10
    v_lshlrev_b32 v4, 4, v1
    v_mov_b32 v5, 0
    buffer_load_dwordx4 v[8:11], v4, s[48:51], s75 offen
    buffer_load_dwordx4 v[12:15], v4, s[48:51], s75 offen offset:1024
    buffer_load_dwordx4 v[16:19], v4, s[64:67], 0 offen
    s_mov_b32 s76, 0
    s_lshl_b32 s84, s38, 2
    s_add_u32 s84, s84, s29
    s_cmp_lg_u32 s28, 1
    s_cbranch_scc1 C_TLBX
    v_lshlrev_b32 v21, 21, v1
    s_mov_b32 s80, s12
    s_and_b32 s81, s13, 0xffff
    s_mov_b32 s82, 0x700000
    s_mov_b32 s83, 0x20000
    buffer_load_dword v20, v21, s[80:83], 0 offen
    s_mov_b32 s80, s16
    s_and_b32 s81, s17, 0xffff
    s_mov_b32 s82, 0x700000
    s_mov_b32 s83, 0x20000
    buffer_load_dword v20, v21, s[80:83], 0 offen
    s_mov_b32 s80, s8
    s_and_b32 s81, s9, 0xffff
    s_mov_b32 s82, 0x80000
    s_mov_b32 s83, 0x20000
    buffer_load_dword v20, v21, s[80:83], 0 offen
    s_mov_b32 s80, s22
    s_and_b32 s81, s23, 0xffff
    s_mov_b32 s82, 0x200000
    s_mov_b32 s83, 0x20000
    buffer_load_dword v20, v21, s[80:83], 0 offen
    s_add_u32 s80, s26, 0x5ff000
    s_addc_u32 s81, s27, 0
    s_and_b32 s81, s81, 0xffff
    s_mov_b32 s82, 0x400000
    s_mov_b32 s83, 0x20000
    buffer_load_dword v20, v21, s[80:83], 0 offen
    s_mov_b32 s80, s14
    s_and_b32 s81, s15, 0xffff
    s_mov_b32 s82, 0xe00
    s_mov_b32 s83, 0x20000
    buffer_load_dword v20, v21, s[80:83], 0 offen
    s_mov_b32 s80, s18
    s_and_b32 s81, s19, 0xffff
    s_mov_b32 s82, 0x1000
    s_mov_b32 s83, 0x20000
    buffer_load_dword v20, v21, s[80:83], 0 offen
C_TLBX:
    s_cmp_lg_u32 s28, 0
    s_cbranch_scc1 C_TOK0
    s_cmp_lg_u32 s2, 0
    s_cbranch_scc1 C_TOK0
    s_memrealtime s[72:73]
    s_waitcnt lgkmcnt(0)
    s_or_b32 s31, s72, 1
    v_mov_b32 v2, s31
    s_mov_b64 exec, 1
    buffer_store_dword v2, v5, s[68:71], 0 offen sc1
    s_mov_b64 exec, -1
C_TOK0:
    s_mov_b32 s85, 0
    v_lshrrev_b32 v29, 5, v1
    v_lshlrev_b32 v29, 3, v29
    v_bfe_u32 v2, v1, 2, 2
    v_add_u32 v29, v29, v2
    v_lshlrev_b32 v29, 7, v29
    v_bfe_u32 v2, v1, 3, 1
    v_xor_b32 v2, 0, v2
    v_lshl_add_u32 v29, v2, 6, v29
    v_bfe_u32 v2, v1, 4, 1
    v_lshl_add_u32 v29, v2, 5, v29
    v_bfe_u32 v2, v1, 1, 1
    v_lshl_add_u32 v29, v2, 4, v29
    v_and_b32 v2, 1, v1
    v_lshl_add_u32 v29, v2, 3, v29
    v_lshrrev_b32 v30, 5, v1
    v_lshlrev_b32 v30, 3, v30
    v_bfe_u32 v2, v1, 2, 2
    v_add_u32 v30, v30, v2
    v_lshlrev_b32 v30, 7, v30
    v_bfe_u32 v2, v1, 3, 1
    v_xor_b32 v2, 1, v2
    v_lshl_add_u32 v30, v2, 6, v30
    v_bfe_u32 v2, v1, 4, 1
    v_lshl_add_u32 v30, v2, 5, v30
    v_bfe_u32 v2, v1, 1, 1
    v_lshl_add_u32 v30, v2, 4, v30
    v_and_b32 v2, 1, v1
    v_lshl_add_u32 v30, v2, 3, v30
    s_add_u32 s31, s29, 1
    s_cmp_eq_u32 s29, 2
    s_cselect_b32 s31, 0, s31
    s_cmp_eq_u32 s29, 3
    s_cselect_b32 s31, 1, s31
    s_cselect_b32 s32, 0, 4096
    s_lshl_b32 s31, s31, 13
    s_add_u32 s31, s31, 12288
    v_add_u32 v29, s31, v29
    v_add_u32 v30, s31, v30
    v_bfe_u32 v2, v1, 1, 3
    v_lshrrev_b32 v3, 5, v1
    v_xor_b32 v2, v2, v3
    v_and_b32 v3, 31, v1
    v_lshlrev_b32 v3, 7, v3
    v_xor_b32 v31, 0, v2
    v_lshl_add_u32 v31, v31, 4, v3
    v_xor_b32 v32, 2, v2
    v_lshl_add_u32 v32, v32, 4, v3
    v_xor_b32 v33, 4, v2
    v_lshl_add_u32 v33, v33, 4, v3
    v_xor_b32 v34, 6, v2
    v_lshl_add_u32 v34, v34, 4, v3
    v_add_u32 v31, s32, v31
    v_add_u32 v32, s32, v32
    v_add_u32 v33, s32, v33
    v_add_u32 v34, s32, v34
    v_mov_b32 v40, 0
    v_mov_b32 v41, 0
    v_mov_b32 v42, 0
    v_mov_b32 v43, 0
    v_mov_b32 v44, 0
    v_mov_b32 v45, 0
    v_mov_b32 v46, 0
    v_mov_b32 v47, 0
    v_mov_b32 v48, 0
    v_mov_b32 v49, 0
    v_mov_b32 v50, 0
    v_mov_b32 v51, 0
    v_mov_b32 v52, 0
    v_mov_b32 v53, 0
    v_mov_b32 v54, 0
    v_mov_b32 v55, 0
    v_mov_b32 v56, 0
    v_mov_b32 v57, 0
    v_mov_b32 v58, 0
    v_mov_b32 v59, 0
    v_mov_b32 v60, 0
    v_mov_b32 v61, 0
    v_mov_b32 v62, 0
    v_mov_b32 v63, 0
    v_mov_b32 v64, 0
    v_mov_b32 v65, 0
    v_mov_b32 v66, 0
    v_mov_b32 v67, 0
    v_mov_b32 v68, 0
    v_mov_b32 v69, 0
    v_mov_b32 v70, 0
    v_mov_b32 v71, 0
    v_mov_b32 v72, 0
    v_mov_b32 v73, 0
    v_mov_b32 v74, 0
    v_mov_b32 v75, 0
    v_mov_b32 v76, 0
    v_mov_b32 v77, 0
    v_mov_b32 v78, 0
    v_mov_b32 v79, 0
    v_mov_b32 v80, 0
    v_mov_b32 v81, 0
    v_mov_b32 v82, 0
    v_mov_b32 v83, 0
    v_mov_b32 v84, 0
    v_mov_b32 v85, 0
    v_mov_b32 v86, 0
    v_mov_b32 v87, 0
    v_mov_b32 v88, 0
    v_mov_b32 v89, 0
    v_mov_b32 v90, 0
    v_mov_b32 v91, 0
    v_mov_b32 v92, 0
    v_mov_b32 v93, 0
    v_mov_b32 v94, 0
    v_mov_b32 v95, 0
    v_mov_b32 v96, 0
    v_mov_b32 v97, 0
    v_mov_b32 v98, 0
    v_mov_b32 v99, 0
    v_mov_b32 v100, 0
    v_mov_b32 v101, 0
    v_mov_b32 v102, 0
    v_mov_b32 v103, 0
    s_cmp_eq_u32 s28, 1
    s_cbranch_scc1 C_LNW
    s_waitcnt vmcnt(0)
C_LNW:
    s_waitcnt vmcnt(7)
    buffer_load_dword v25, v5, s[68:71], 0 offen sc1
    v_lshlrev_b32 v216, 16, v16
    v_and_b32 v217, 0xffff0000, v16
    v_lshlrev_b32 v218, 16, v17
    v_and_b32 v219, 0xffff0000, v17
    v_lshlrev_b32 v220, 16, v18
    v_and_b32 v221, 0xffff0000, v18
    v_lshlrev_b32 v222, 16, v19
    v_and_b32 v223, 0xffff0000, v19
    v_lshlrev_b32 v200, 16, v8
    v_and_b32 v201, 0xffff0000, v8
    v_lshlrev_b32 v202, 16, v9
    v_and_b32 v203, 0xffff0000, v9
    v_lshlrev_b32 v204, 16, v10
    v_and_b32 v205, 0xffff0000, v10
    v_lshlrev_b32 v206, 16, v11
    v_and_b32 v207, 0xffff0000, v11
    v_add_f32 v224, v200, v201
    v_add_f32 v224, v224, v202
    v_add_f32 v224, v224, v203
    v_add_f32 v224, v224, v204
    v_add_f32 v224, v224, v205
    v_add_f32 v224, v224, v206
    v_add_f32 v224, v224, v207
    v_mul_f32 v232, v200, v216
    v_mul_f32 v233, v201, v217
    v_mul_f32 v234, v202, v218
    v_mul_f32 v235, v203, v219
    v_mul_f32 v236, v204, v220
    v_mul_f32 v237, v205, v221
    v_mul_f32 v238, v206, v222
    v_mul_f32 v239, v207, v223
    v_cvt_pk_bf16_f32 v232, v232, v233
    v_cvt_pk_bf16_f32 v234, v234, v235
    v_cvt_pk_bf16_f32 v236, v236, v237
    v_cvt_pk_bf16_f32 v238, v238, v239
    v_and_b32 v233, 0xffff0000, v232
    v_lshlrev_b32 v232, 16, v232
    v_and_b32 v235, 0xffff0000, v234
    v_lshlrev_b32 v234, 16, v234
    v_and_b32 v237, 0xffff0000, v236
    v_lshlrev_b32 v236, 16, v236
    v_and_b32 v239, 0xffff0000, v238
    v_lshlrev_b32 v238, 16, v238
    v_add_f32 v226, v232, v233
    v_add_f32 v226, v226, v234
    v_add_f32 v226, v226, v235
    v_add_f32 v226, v226, v236
    v_add_f32 v226, v226, v237
    v_add_f32 v226, v226, v238
    v_add_f32 v226, v226, v239
    v_lshlrev_b32 v208, 16, v12
    v_and_b32 v209, 0xffff0000, v12
    v_lshlrev_b32 v210, 16, v13
    v_and_b32 v211, 0xffff0000, v13
    v_lshlrev_b32 v212, 16, v14
    v_and_b32 v213, 0xffff0000, v14
    v_lshlrev_b32 v214, 16, v15
    v_and_b32 v215, 0xffff0000, v15
    v_add_f32 v225, v208, v209
    v_add_f32 v225, v225, v210
    v_add_f32 v225, v225, v211
    v_add_f32 v225, v225, v212
    v_add_f32 v225, v225, v213
    v_add_f32 v225, v225, v214
    v_add_f32 v225, v225, v215
    v_mul_f32 v232, v208, v216
    v_mul_f32 v233, v209, v217
    v_mul_f32 v234, v210, v218
    v_mul_f32 v235, v211, v219
    v_mul_f32 v236, v212, v220
    v_mul_f32 v237, v213, v221
    v_mul_f32 v238, v214, v222
    v_mul_f32 v239, v215, v223
    v_cvt_pk_bf16_f32 v232, v232, v233
    v_cvt_pk_bf16_f32 v234, v234, v235
    v_cvt_pk_bf16_f32 v236, v236, v237
    v_cvt_pk_bf16_f32 v238, v238, v239
    v_and_b32 v233, 0xffff0000, v232
    v_lshlrev_b32 v232, 16, v232
    v_and_b32 v235, 0xffff0000, v234
    v_lshlrev_b32 v234, 16, v234
    v_and_b32 v237, 0xffff0000, v236
    v_lshlrev_b32 v236, 16, v236
    v_and_b32 v239, 0xffff0000, v238
    v_lshlrev_b32 v238, 16, v238
    v_add_f32 v227, v232, v233
    v_add_f32 v227, v227, v234
    v_add_f32 v227, v227, v235
    v_add_f32 v227, v227, v236
    v_add_f32 v227, v227, v237
    v_add_f32 v227, v227, v238
    v_add_f32 v227, v227, v239
    s_nop 1
    v_add_f32_dpp v228, v224, v224 quad_perm:[1,0,3,2] row_mask:0xf bank_mask:0xf
    v_add_f32_dpp v229, v225, v225 quad_perm:[1,0,3,2] row_mask:0xf bank_mask:0xf
    v_add_f32_dpp v230, v226, v226 quad_perm:[1,0,3,2] row_mask:0xf bank_mask:0xf
    v_add_f32_dpp v231, v227, v227 quad_perm:[1,0,3,2] row_mask:0xf bank_mask:0xf
    v_add_f32_dpp v224, v228, v228 quad_perm:[2,3,0,1] row_mask:0xf bank_mask:0xf
    v_add_f32_dpp v225, v229, v229 quad_perm:[2,3,0,1] row_mask:0xf bank_mask:0xf
    v_add_f32_dpp v226, v230, v230 quad_perm:[2,3,0,1] row_mask:0xf bank_mask:0xf
    v_add_f32_dpp v227, v231, v231 quad_perm:[2,3,0,1] row_mask:0xf bank_mask:0xf
    v_add_f32_dpp v228, v224, v224 row_half_mirror row_mask:0xf bank_mask:0xf
    v_add_f32_dpp v229, v225, v225 row_half_mirror row_mask:0xf bank_mask:0xf
    v_add_f32_dpp v230, v226, v226 row_half_mirror row_mask:0xf bank_mask:0xf
    v_add_f32_dpp v231, v227, v227 row_half_mirror row_mask:0xf bank_mask:0xf
    v_add_f32_dpp v224, v228, v228 row_mirror row_mask:0xf bank_mask:0xf
    v_add_f32_dpp v225, v229, v229 row_mirror row_mask:0xf bank_mask:0xf
    v_add_f32_dpp v226, v230, v230 row_mirror row_mask:0xf bank_mask:0xf
    v_add_f32_dpp v227, v231, v231 row_mirror row_mask:0xf bank_mask:0xf
    v_mov_b32 v228, v224
    v_mov_b32 v229, v225
    v_mov_b32 v230, v226
    v_mov_b32 v231, v227
    s_nop 1
    v_permlane16_swap_b32 v228, v224
    v_permlane16_swap_b32 v229, v225
    v_permlane16_swap_b32 v230, v226
    v_permlane16_swap_b32 v231, v227
    s_nop 1
    v_add_f32 v224, v224, v228
    v_add_f32 v225, v225, v229
    v_add_f32 v226, v226, v230
    v_add_f32 v227, v227, v231
    v_mov_b32 v228, v224
    v_mov_b32 v229, v225
    v_mov_b32 v230, v226
    v_mov_b32 v231, v227
    s_nop 1
    v_permlane32_swap_b32 v228, v224
    v_permlane32_swap_b32 v229, v225
    v_permlane32_swap_b32 v230, v226
    v_permlane32_swap_b32 v231, v227
    s_nop 1
    v_add_f32 v224, v224, v228
    v_add_f32 v225, v225, v229
    v_add_f32 v226, v226, v230
    v_add_f32 v227, v227, v231
    v_mul_f32 v224, 0x3b000000, v224
    v_mul_f32 v225, 0x3b000000, v225
    v_sub_f32 v232, v200, v224
    v_sub_f32 v233, v201, v224
    v_sub_f32 v234, v202, v224
    v_sub_f32 v235, v203, v224
    v_sub_f32 v236, v204, v224
    v_sub_f32 v237, v205, v224
    v_sub_f32 v238, v206, v224
    v_sub_f32 v239, v207, v224
    v_mul_f32 v228, v232, v232
    v_fmac_f32 v228, v233, v233
    v_fmac_f32 v228, v234, v234
    v_fmac_f32 v228, v235, v235
    v_fmac_f32 v228, v236, v236
    v_fmac_f32 v228, v237, v237
    v_fmac_f32 v228, v238, v238
    v_fmac_f32 v228, v239, v239
    v_sub_f32 v232, v208, v225
    v_sub_f32 v233, v209, v225
    v_sub_f32 v234, v210, v225
    v_sub_f32 v235, v211, v225
    v_sub_f32 v236, v212, v225
    v_sub_f32 v237, v213, v225
    v_sub_f32 v238, v214, v225
    v_sub_f32 v239, v215, v225
    v_mul_f32 v229, v232, v232
    v_fmac_f32 v229, v233, v233
    v_fmac_f32 v229, v234, v234
    v_fmac_f32 v229, v235, v235
    v_fmac_f32 v229, v236, v236
    v_fmac_f32 v229, v237, v237
    v_fmac_f32 v229, v238, v238
    v_fmac_f32 v229, v239, v239
    s_nop 1
    v_add_f32_dpp v230, v228, v228 quad_perm:[1,0,3,2] row_mask:0xf bank_mask:0xf
    v_add_f32_dpp v231, v229, v229 quad_perm:[1,0,3,2] row_mask:0xf bank_mask:0xf
    s_nop 1
    v_add_f32_dpp v228, v230, v230 quad_perm:[2,3,0,1] row_mask:0xf bank_mask:0xf
    v_add_f32_dpp v229, v231, v231 quad_perm:[2,3,0,1] row_mask:0xf bank_mask:0xf
    s_nop 1
    v_add_f32_dpp v230, v228, v228 row_half_mirror row_mask:0xf bank_mask:0xf
    v_add_f32_dpp v231, v229, v229 row_half_mirror row_mask:0xf bank_mask:0xf
    s_nop 1
    v_add_f32_dpp v228, v230, v230 row_mirror row_mask:0xf bank_mask:0xf
    v_add_f32_dpp v229, v231, v231 row_mirror row_mask:0xf bank_mask:0xf
    s_nop 1
    v_mov_b32 v230, v228
    v_mov_b32 v231, v229
    s_nop 1
    v_permlane16_swap_b32 v230, v228
    v_permlane16_swap_b32 v231, v229
    s_nop 1
    v_add_f32 v228, v228, v230
    v_add_f32 v229, v229, v231
    s_nop 1
    v_mov_b32 v230, v228
    v_mov_b32 v231, v229
    s_nop 1
    v_permlane32_swap_b32 v230, v228
    v_permlane32_swap_b32 v231, v229
    s_nop 1
    v_add_f32 v228, v228, v230
    v_add_f32 v229, v229, v231
    s_nop 1
    v_mul_f32 v228, 0x3b000000, v228
    v_cvt_pk_bf16_f32 v228, v228, v228
    v_lshlrev_b32 v228, 16, v228
    v_add_f32 v228, 0x3727c5ac, v228
    v_cvt_pk_bf16_f32 v228, v228, v228
    v_lshlrev_b32 v228, 16, v228
    v_sqrt_f32 v228, v228
    s_nop 0
    v_cvt_pk_bf16_f32 v228, v228, v228
    v_lshlrev_b32 v228, 16, v228
    v_rcp_f32 v228, v228
    v_cvt_pk_bf16_f32 v224, v224, v224
    v_lshlrev_b32 v224, 16, v224
    v_sub_f32 v232, v200, v224
    v_sub_f32 v233, v201, v224
    v_sub_f32 v234, v202, v224
    v_sub_f32 v235, v203, v224
    v_sub_f32 v236, v204, v224
    v_sub_f32 v237, v205, v224
    v_sub_f32 v238, v206, v224
    v_sub_f32 v239, v207, v224
    v_cvt_pk_bf16_f32 v232, v232, v233
    v_cvt_pk_bf16_f32 v234, v234, v235
    v_cvt_pk_bf16_f32 v236, v236, v237
    v_cvt_pk_bf16_f32 v238, v238, v239
    v_and_b32 v233, 0xffff0000, v232
    v_lshlrev_b32 v232, 16, v232
    v_and_b32 v235, 0xffff0000, v234
    v_lshlrev_b32 v234, 16, v234
    v_and_b32 v237, 0xffff0000, v236
    v_lshlrev_b32 v236, 16, v236
    v_and_b32 v239, 0xffff0000, v238
    v_lshlrev_b32 v238, 16, v238
    v_mul_f32 v232, v232, v228
    v_mul_f32 v233, v233, v228
    v_mul_f32 v234, v234, v228
    v_mul_f32 v235, v235, v228
    v_mul_f32 v236, v236, v228
    v_mul_f32 v237, v237, v228
    v_mul_f32 v238, v238, v228
    v_mul_f32 v239, v239, v228
    v_cvt_pk_bf16_f32 v8, v232, v233
    v_cvt_pk_bf16_f32 v9, v234, v235
    v_cvt_pk_bf16_f32 v10, v236, v237
    v_cvt_pk_bf16_f32 v11, v238, v239
    buffer_store_dwordx4 v[8:11], v4, s[52:55], s75 offen offset:0 sc1
    v_mul_f32 v229, 0x3b000000, v229
    v_cvt_pk_bf16_f32 v229, v229, v229
    v_lshlrev_b32 v229, 16, v229
    v_add_f32 v229, 0x3727c5ac, v229
    v_cvt_pk_bf16_f32 v229, v229, v229
    v_lshlrev_b32 v229, 16, v229
    v_sqrt_f32 v229, v229
    s_nop 0
    v_cvt_pk_bf16_f32 v229, v229, v229
    v_lshlrev_b32 v229, 16, v229
    v_rcp_f32 v229, v229
    v_cvt_pk_bf16_f32 v225, v225, v225
    v_lshlrev_b32 v225, 16, v225
    v_sub_f32 v232, v208, v225
    v_sub_f32 v233, v209, v225
    v_sub_f32 v234, v210, v225
    v_sub_f32 v235, v211, v225
    v_sub_f32 v236, v212, v225
    v_sub_f32 v237, v213, v225
    v_sub_f32 v238, v214, v225
    v_sub_f32 v239, v215, v225
    v_cvt_pk_bf16_f32 v232, v232, v233
    v_cvt_pk_bf16_f32 v234, v234, v235
    v_cvt_pk_bf16_f32 v236, v236, v237
    v_cvt_pk_bf16_f32 v238, v238, v239
    v_and_b32 v233, 0xffff0000, v232
    v_lshlrev_b32 v232, 16, v232
    v_and_b32 v235, 0xffff0000, v234
    v_lshlrev_b32 v234, 16, v234
    v_and_b32 v237, 0xffff0000, v236
    v_lshlrev_b32 v236, 16, v236
    v_and_b32 v239, 0xffff0000, v238
    v_lshlrev_b32 v238, 16, v238
    v_mul_f32 v232, v232, v229
    v_mul_f32 v233, v233, v229
    v_mul_f32 v234, v234, v229
    v_mul_f32 v235, v235, v229
    v_mul_f32 v236, v236, v229
    v_mul_f32 v237, v237, v229
    v_mul_f32 v238, v238, v229
    v_mul_f32 v239, v239, v229
    v_cvt_pk_bf16_f32 v12, v232, v233
    v_cvt_pk_bf16_f32 v13, v234, v235
    v_cvt_pk_bf16_f32 v14, v236, v237
    v_cvt_pk_bf16_f32 v15, v238, v239
    buffer_store_dwordx4 v[12:15], v4, s[52:55], s75 offen offset:1024 sc1
    v_cvt_pk_bf16_f32 v226, v226, v226
    v_lshlrev_b32 v226, 16, v226
    v_mul_f32 v226, 0xbfb8aa3b, v226
    v_exp_f32 v226, v226
    s_nop 0
    v_add_f32 v226, 1.0, v226
    v_rcp_f32 v226, v226
    s_nop 0
    v_cvt_pk_bf16_f32 v226, v226, v226
    v_lshlrev_b32 v226, 16, v226
    v_cvt_pk_bf16_f32 v227, v227, v227
    v_lshlrev_b32 v227, 16, v227
    v_mul_f32 v227, 0xbfb8aa3b, v227
    v_exp_f32 v227, v227
    s_nop 0
    v_add_f32 v227, 1.0, v227
    v_rcp_f32 v227, v227
    s_nop 0
    v_cvt_pk_bf16_f32 v227, v227, v227
    v_lshlrev_b32 v227, 16, v227
    v_mov_b32 v232, v226
    v_mov_b32 v233, v227
    s_lshl_b32 s31, s74, 2
    s_mov_b64 exec, 1
    buffer_store_dwordx2 v[232:233], v5, s[60:63], s31 offen sc1
    s_mov_b64 exec, -1
    v_lshlrev_b32 v28, 10, v1
    s_mov_b32 s87, 0xff
    s_lshl_b32 s31, s2, 2
    s_mov_b32 s86, s31
    s_mov_b32 s85, 147460
    s_mov_b32 s76, 0
    s_cmp_lg_u32 s28, 0
    s_cbranch_scc1 C_TOKD
    s_mov_b32 s32, 0
    s_waitcnt vmcnt(3)
    v_readfirstlane_b32 s31, v25
    s_cmp_lg_u32 s31, 0
    s_cbranch_scc1 C_TOK1
C_TOK:
    buffer_load_dword v2, v5, s[68:71], 0 offen sc1
    s_waitcnt vmcnt(0)
    v_readfirstlane_b32 s31, v2
    s_add_u32 s32, s32, 1
    s_cmp_ge_u32 s32, 0x4000
    s_cbranch_scc1 C_TOK1
    s_cmp_lg_u32 s31, 0
    s_cbranch_scc1 C_TOK1
    s_sleep 1
    s_branch C_TOK
C_TOK1:
    v_mov_b32 v24, s31
    v_mov_b32 v25, 0
    v_mov_b32 v26, 0
    v_mov_b32 v27, 0
    v_mov_b32 v2, 147456
    s_mov_b64 exec, 1
    ds_write_b128 v2, v[24:27]
    v_mov_b32 v24, 0
    ds_write_b128 v2, v[24:27] offset:16
    s_mov_b64 exec, -1
C_TOKD:
    s_mov_b32 s88, 0
    s_mov_b32 s39, 0
    s_mov_b32 s74, 4
    s_waitcnt lgkmcnt(0)
    s_barrier
    v_mov_b32 v2, 147456
    ds_read_b32 v2, v2
    s_waitcnt lgkmcnt(0)
    v_readfirstlane_b32 s40, v2
C_P1_ENTER:
    s_cmp_eq_u32 s29, 3
    s_cbranch_scc1 C_P1_ENTER1
    ds_read_b64_tr_b16 v[104:105], v29 offset:0
    ds_read_b64_tr_b16 v[106:107], v29 offset:512
    ds_read_b128 v[120:123], v31
    ds_read_b128 v[124:127], v31 offset:4096
    ds_read_b64_tr_b16 v[108:109], v30 offset:0
    ds_read_b64_tr_b16 v[110:111], v30 offset:512
    ds_read_b64_tr_b16 v[128:129], v29 offset:2048
    ds_read_b64_tr_b16 v[130:131], v29 offset:2560
    ds_read_b128 v[144:147], v32
    ds_read_b128 v[148:151], v32 offset:4096
    ds_read_b64_tr_b16 v[132:133], v30 offset:2048
    ds_read_b64_tr_b16 v[134:135], v30 offset:2560
C_P1v0:
    s_waitcnt lgkmcnt(6)
    v_mfma_f32_32x32x16_bf16 v[40:55], v[104:107], v[120:123], v[40:55]
    ds_read_b64_tr_b16 v[152:153], v29 offset:4096
    ds_read_b64_tr_b16 v[154:155], v29 offset:4608
    v_mfma_f32_32x32x16_bf16 v[56:71], v[104:107], v[124:127], v[56:71]
    ds_read_b128 v[168:171], v33
    ds_read_b128 v[172:175], v33 offset:4096
    v_mfma_f32_32x32x16_bf16 v[72:87], v[108:111], v[120:123], v[72:87]
    ds_read_b64_tr_b16 v[156:157], v30 offset:4096
    ds_read_b64_tr_b16 v[158:159], v30 offset:4608
    v_mfma_f32_32x32x16_bf16 v[88:103], v[108:111], v[124:127], v[88:103]
    s_waitcnt lgkmcnt(6)
    v_mfma_f32_32x32x16_bf16 v[40:55], v[128:131], v[144:147], v[40:55]
    ds_read_b64_tr_b16 v[176:177], v29 offset:6144
    ds_read_b64_tr_b16 v[178:179], v29 offset:6656
    v_mfma_f32_32x32x16_bf16 v[56:71], v[128:131], v[148:151], v[56:71]
    ds_read_b128 v[192:195], v34
    ds_read_b128 v[196:199], v34 offset:4096
    v_mfma_f32_32x32x16_bf16 v[72:87], v[132:135], v[144:147], v[72:87]
    ds_read_b64_tr_b16 v[180:181], v30 offset:6144
    ds_read_b64_tr_b16 v[182:183], v30 offset:6656
    v_mfma_f32_32x32x16_bf16 v[88:103], v[132:135], v[148:151], v[88:103]
    s_cmp_eq_u32 s39, s74
    s_cbranch_scc1 C_P1v0_LAST
    s_lshr_b32 s31, s38, 3
    s_cmp_lg_u32 s39, s31
    s_cbranch_scc1 C_P1v0_NW
    s_mov_b32 s80, s12
    s_and_b32 s81, s13, 0xffff
    s_mov_b32 s82, 0x700000
    s_mov_b32 s83, 0x20000
    v_lshrrev_b32 v21, 3, v1
    s_movk_i32 s31, 3584
    v_mul_lo_u32 v21, v21, s31
    v_and_b32 v2, 7, v1
    v_lshl_add_u32 v21, v2, 7, v21
    s_mul_i32 s31, s84, 57344
    s_bfe_u32 s32, s2, 0x20001
    s_mul_i32 s32, s32, 896
    s_add_u32 s31, s31, s32
    buffer_load_dword v20, v21, s[80:83], s31 offen
    s_add_u32 s31, s31, 28672
    buffer_load_dword v20, v21, s[80:83], s31 offen
    s_add_u32 s76, s76, 2
C_P1v0_NW:
    s_cmp_eq_u32 s85, 0
    s_cbranch_scc1 C_P1v0_SH_S
C_P1v0_SH_R:
    s_getreg_b32 s31, hwreg(HW_REG_IB_STS)
    s_lshr_b32 s32, s31, 18
    s_and_b32 s32, s32, 0x30
    s_and_b32 s31, s31, 15
    s_or_b32 s31, s31, s32
    s_cmp_gt_u32 s31, s76
    s_cbranch_scc1 C_P1v0_SH_S
    v_mov_b32 v2, s85
    v_mov_b32 v3, 1
    s_mov_b32 s85, 0
    s_mov_b64 exec, 1
    ds_add_rtn_u32 v3, v2, v3
    s_waitcnt lgkmcnt(0)
    v_readfirstlane_b32 s31, v3
    s_cmp_lg_u32 s31, 3
    s_cbranch_scc1 C_P1v0_SH_N
    s_mov_b32 exec_lo, s87
    v_mov_b32 v3, s40
    buffer_store_dword v3, v28, s[44:47], s86 offen sc1
C_P1v0_SH_N:
    s_mov_b64 exec, -1
C_P1v0_SH_S:
    s_barrier
    s_add_u32 s89, s88, 36864
    s_cmp_eq_u32 s89, 147456
    s_cselect_b32 s89, 0, s89
    s_xor_b32 s89, s89, s88
    s_xor_b32 s88, s88, s89
    s_xor_b32 s89, s89, s88
    s_sub_u32 s89, s88, s89
    v_add_u32 v29, s89, v29
    v_add_u32 v30, s89, v30
    v_add_u32 v31, s89, v31
    v_add_u32 v32, s89, v32
    v_add_u32 v33, s89, v33
    v_add_u32 v34, s89, v34
    s_waitcnt lgkmcnt(6)
    v_mfma_f32_32x32x16_bf16 v[40:55], v[152:155], v[168:171], v[40:55]
    ds_read_b64_tr_b16 v[104:105], v29 offset:0
    ds_read_b64_tr_b16 v[106:107], v29 offset:512
    v_mfma_f32_32x32x16_bf16 v[56:71], v[152:155], v[172:175], v[56:71]
    ds_read_b128 v[120:123], v31
    ds_read_b128 v[124:127], v31 offset:4096
    v_mfma_f32_32x32x16_bf16 v[72:87], v[156:159], v[168:171], v[72:87]
    ds_read_b64_tr_b16 v[108:109], v30 offset:0
    ds_read_b64_tr_b16 v[110:111], v30 offset:512
    v_mfma_f32_32x32x16_bf16 v[88:103], v[156:159], v[172:175], v[88:103]
    s_waitcnt lgkmcnt(6)
    v_mfma_f32_32x32x16_bf16 v[40:55], v[176:179], v[192:195], v[40:55]
    ds_read_b64_tr_b16 v[128:129], v29 offset:2048
    ds_read_b64_tr_b16 v[130:131], v29 offset:2560
    v_mfma_f32_32x32x16_bf16 v[56:71], v[176:179], v[196:199], v[56:71]
    ds_read_b128 v[144:147], v32
    ds_read_b128 v[148:151], v32 offset:4096
    v_mfma_f32_32x32x16_bf16 v[72:87], v[180:183], v[192:195], v[72:87]
    ds_read_b64_tr_b16 v[132:133], v30 offset:2048
    ds_read_b64_tr_b16 v[134:135], v30 offset:2560
    v_mfma_f32_32x32x16_bf16 v[88:103], v[180:183], v[196:199], v[88:103]
    s_add_u32 s39, s39, 1
    s_branch C_P1v0
C_P1v0_LAST:
    s_waitcnt lgkmcnt(6)
    v_mfma_f32_32x32x16_bf16 v[40:55], v[152:155], v[168:171], v[40:55]
    v_mfma_f32_32x32x16_bf16 v[56:71], v[152:155], v[172:175], v[56:71]
    v_mfma_f32_32x32x16_bf16 v[72:87], v[156:159], v[168:171], v[72:87]
    v_mfma_f32_32x32x16_bf16 v[88:103], v[156:159], v[172:175], v[88:103]
    s_waitcnt lgkmcnt(0)
    v_mfma_f32_32x32x16_bf16 v[40:55], v[176:179], v[192:195], v[40:55]
    v_mfma_f32_32x32x16_bf16 v[56:71], v[176:179], v[196:199], v[56:71]
    v_mfma_f32_32x32x16_bf16 v[72:87], v[180:183], v[192:195], v[72:87]
    v_mfma_f32_32x32x16_bf16 v[88:103], v[180:183], v[196:199], v[88:103]
    s_branch C_P1_EXIT
C_P1_ENTER1:
    ds_read_b128 v[120:123], v31
    ds_read_b64_tr_b16 v[104:105], v29 offset:0
    ds_read_b64_tr_b16 v[106:107], v29 offset:512
    ds_read_b64_tr_b16 v[108:109], v30 offset:0
    ds_read_b64_tr_b16 v[110:111], v30 offset:512
    ds_read_b64_tr_b16 v[112:113], v29 offset:8192
    ds_read_b64_tr_b16 v[114:115], v29 offset:8704
    ds_read_b64_tr_b16 v[116:117], v30 offset:8192
    ds_read_b64_tr_b16 v[118:119], v30 offset:8704
    ds_read_b128 v[144:147], v32
    ds_read_b64_tr_b16 v[128:129], v29 offset:2048
    ds_read_b64_tr_b16 v[130:131], v29 offset:2560
    ds_read_b64_tr_b16 v[132:133], v30 offset:2048
    ds_read_b64_tr_b16 v[134:135], v30 offset:2560
    ds_read_b64_tr_b16 v[136:137], v29 offset:10240
    ds_read_b64_tr_b16 v[138:139], v29 offset:10752
    ds_read_b64_tr_b16 v[140:141], v30 offset:10240
    ds_read_b64_tr_b16 v[142:143], v30 offset:10752
C_P1v1:
    s_waitcnt lgkmcnt(9)
    v_mfma_f32_32x32x16_bf16 v[40:55], v[104:107], v[120:123], v[40:55]
    ds_read_b128 v[168:171], v33
    ds_read_b64_tr_b16 v[152:153], v29 offset:4096
    ds_read_b64_tr_b16 v[154:155], v29 offset:4608
    v_mfma_f32_32x32x16_bf16 v[56:71], v[108:111], v[120:123], v[56:71]
    ds_read_b64_tr_b16 v[156:157], v30 offset:4096
    ds_read_b64_tr_b16 v[158:159], v30 offset:4608
    ds_read_b64_tr_b16 v[160:161], v29 offset:12288
    v_mfma_f32_32x32x16_bf16 v[72:87], v[112:115], v[120:123], v[72:87]
    ds_read_b64_tr_b16 v[162:163], v29 offset:12800
    ds_read_b64_tr_b16 v[164:165], v30 offset:12288
    ds_read_b64_tr_b16 v[166:167], v30 offset:12800
    v_mfma_f32_32x32x16_bf16 v[88:103], v[116:119], v[120:123], v[88:103]
    s_waitcnt lgkmcnt(9)
    v_mfma_f32_32x32x16_bf16 v[40:55], v[128:131], v[144:147], v[40:55]
    ds_read_b128 v[192:195], v34
    ds_read_b64_tr_b16 v[176:177], v29 offset:6144
    ds_read_b64_tr_b16 v[178:179], v29 offset:6656
    v_mfma_f32_32x32x16_bf16 v[56:71], v[132:135], v[144:147], v[56:71]
    ds_read_b64_tr_b16 v[180:181], v30 offset:6144
    ds_read_b64_tr_b16 v[182:183], v30 offset:6656
    ds_read_b64_tr_b16 v[184:185], v29 offset:14336
    v_mfma_f32_32x32x16_bf16 v[72:87], v[136:139], v[144:147], v[72:87]
    ds_read_b64_tr_b16 v[186:187], v29 offset:14848
    ds_read_b64_tr_b16 v[188:189], v30 offset:14336
    ds_read_b64_tr_b16 v[190:191], v30 offset:14848
    v_mfma_f32_32x32x16_bf16 v[88:103], v[140:143], v[144:147], v[88:103]
    s_cmp_eq_u32 s39, s74
    s_cbranch_scc1 C_P1v1_LAST
    s_lshr_b32 s31, s38, 3
    s_cmp_lg_u32 s39, s31
    s_cbranch_scc1 C_P1v1_NW
    s_mov_b32 s80, s12
    s_and_b32 s81, s13, 0xffff
    s_mov_b32 s82, 0x700000
    s_mov_b32 s83, 0x20000
    v_lshrrev_b32 v21, 3, v1
    s_movk_i32 s31, 3584
    v_mul_lo_u32 v21, v21, s31
    v_and_b32 v2, 7, v1
    v_lshl_add_u32 v21, v2, 7, v21
    s_mul_i32 s31, s84, 57344
    s_bfe_u32 s32, s2, 0x20001
    s_mul_i32 s32, s32, 896
    s_add_u32 s31, s31, s32
    buffer_load_dword v20, v21, s[80:83], s31 offen
    s_add_u32 s31, s31, 28672
    buffer_load_dword v20, v21, s[80:83], s31 offen
    s_add_u32 s76, s76, 2
C_P1v1_NW:
    s_cmp_eq_u32 s85, 0
    s_cbranch_scc1 C_P1v1_SH_S
C_P1v1_SH_R:
    s_getreg_b32 s31, hwreg(HW_REG_IB_STS)
    s_lshr_b32 s32, s31, 18
    s_and_b32 s32, s32, 0x30
    s_and_b32 s31, s31, 15
    s_or_b32 s31, s31, s32
    s_cmp_gt_u32 s31, s76
    s_cbranch_scc1 C_P1v1_SH_S
    v_mov_b32 v2, s85
    v_mov_b32 v3, 1
    s_mov_b32 s85, 0
    s_mov_b64 exec, 1
    ds_add_rtn_u32 v3, v2, v3
    s_waitcnt lgkmcnt(0)
    v_readfirstlane_b32 s31, v3
    s_cmp_lg_u32 s31, 3
    s_cbranch_scc1 C_P1v1_SH_N
    s_mov_b32 exec_lo, s87
    v_mov_b32 v3, s40
    buffer_store_dword v3, v28, s[44:47], s86 offen sc1
C_P1v1_SH_N:
    s_mov_b64 exec, -1
C_P1v1_SH_S:
    s_barrier
    s_add_u32 s89, s88, 36864
    s_cmp_eq_u32 s89, 147456
    s_cselect_b32 s89, 0, s89
    s_xor_b32 s89, s89, s88
    s_xor_b32 s88, s88, s89
    s_xor_b32 s89, s89, s88
    s_sub_u32 s89, s88, s89
    v_add_u32 v29, s89, v29
    v_add_u32 v30, s89, v30
    v_add_u32 v31, s89, v31
    v_add_u32 v32, s89, v32
    v_add_u32 v33, s89, v33
    v_add_u32 v34, s89, v34
    s_waitcnt lgkmcnt(9)
    v_mfma_f32_32x32x16_bf16 v[40:55], v[152:155], v[168:171], v[40:55]
    ds_read_b128 v[120:123], v31
    ds_read_b64_tr_b16 v[104:105], v29 offset:0
    ds_read_b64_tr_b16 v[106:107], v29 offset:512
    v_mfma_f32_32x32x16_bf16 v[56:71], v[156:159], v[168:171], v[56:71]
    ds_read_b64_tr_b16 v[108:109], v30 offset:0
    ds_read_b64_tr_b16 v[110:111], v30 offset:512
    ds_read_b64_tr_b16 v[112:113], v29 offset:8192
    v_mfma_f32_32x32x16_bf16 v[72:87], v[160:163], v[168:171], v[72:87]
    ds_read_b64_tr_b16 v[114:115], v29 offset:8704
    ds_read_b64_tr_b16 v[116:117], v30 offset:8192
    ds_read_b64_tr_b16 v[118:119], v30 offset:8704
    v_mfma_f32_32x32x16_bf16 v[88:103], v[164:167], v[168:171], v[88:103]
    s_waitcnt lgkmcnt(9)
    v_mfma_f32_32x32x16_bf16 v[40:55], v[176:179], v[192:195], v[40:55]
    ds_read_b128 v[144:147], v32
    ds_read_b64_tr_b16 v[128:129], v29 offset:2048
    ds_read_b64_tr_b16 v[130:131], v29 offset:2560
    v_mfma_f32_32x32x16_bf16 v[56:71], v[180:183], v[192:195], v[56:71]
    ds_read_b64_tr_b16 v[132:133], v30 offset:2048
    ds_read_b64_tr_b16 v[134:135], v30 offset:2560
    ds_read_b64_tr_b16 v[136:137], v29 offset:10240
    v_mfma_f32_32x32x16_bf16 v[72:87], v[184:187], v[192:195], v[72:87]
    ds_read_b64_tr_b16 v[138:139], v29 offset:10752
    ds_read_b64_tr_b16 v[140:141], v30 offset:10240
    ds_read_b64_tr_b16 v[142:143], v30 offset:10752
    v_mfma_f32_32x32x16_bf16 v[88:103], v[188:191], v[192:195], v[88:103]
    s_add_u32 s39, s39, 1
    s_branch C_P1v1
C_P1v1_LAST:
    s_waitcnt lgkmcnt(9)
    v_mfma_f32_32x32x16_bf16 v[40:55], v[152:155], v[168:171], v[40:55]
    v_mfma_f32_32x32x16_bf16 v[56:71], v[156:159], v[168:171], v[56:71]
    v_mfma_f32_32x32x16_bf16 v[72:87], v[160:163], v[168:171], v[72:87]
    v_mfma_f32_32x32x16_bf16 v[88:103], v[164:167], v[168:171], v[88:103]
    s_waitcnt lgkmcnt(0)
    v_mfma_f32_32x32x16_bf16 v[40:55], v[176:179], v[192:195], v[40:55]
    v_mfma_f32_32x32x16_bf16 v[56:71], v[180:183], v[192:195], v[56:71]
    v_mfma_f32_32x32x16_bf16 v[72:87], v[184:187], v[192:195], v[72:87]
    v_mfma_f32_32x32x16_bf16 v[88:103], v[188:191], v[192:195], v[88:103]
C_P1_EXIT:
    s_cmp_eq_u32 s74, 7
    s_cbranch_scc1 C_P1B_DONE
    s_cmp_eq_u32 s85, 0
    s_cbranch_scc1 C_SHF_S
C_SHF_R:
    s_getreg_b32 s31, hwreg(HW_REG_IB_STS)
    s_lshr_b32 s32, s31, 18
    s_and_b32 s32, s32, 0x30
    s_and_b32 s31, s31, 15
    s_or_b32 s31, s31, s32
    s_cmp_gt_u32 s31, s76
    s_cbranch_scc1 C_SHF_R
    v_mov_b32 v2, s85
    v_mov_b32 v3, 1
    s_mov_b32 s85, 0
    s_mov_b64 exec, 1
    ds_add_rtn_u32 v3, v2, v3
    s_waitcnt lgkmcnt(0)
    v_readfirstlane_b32 s31, v3
    s_cmp_lg_u32 s31, 3
    s_cbranch_scc1 C_SHF_N
    s_mov_b32 exec_lo, s87
    v_mov_b32 v3, s40
    buffer_store_dword v3, v28, s[44:47], s86 offen sc1
C_SHF_N:
    s_mov_b64 exec, -1
C_SHF_S:
    s_mov_b32 s48, s14
    s_and_b32 s49, s15, 0xffff
    s_mov_b32 s50, 0xe00
    s_mov_b32 s51, 0x20000
    s_add_u32 s52, s26, 0x400000
    s_addc_u32 s53, s27, 0
    s_and_b32 s53, s53, 0xffff
    s_mov_b32 s54, 0x1c0000
    s_mov_b32 s55, 0x20000
    s_and_b32 s90, s29, 1
    s_lshr_b32 s91, s29, 1
    v_bfe_u32 v2, v1, 1, 3
    v_lshrrev_b32 v3, 5, v1
    v_xor_b32 v2, v2, v3
    v_and_b32 v3, 31, v1
    v_lshlrev_b32 v3, 7, v3
    v_xor_b32 v31, 0, v2
    v_lshl_add_u32 v31, v31, 4, v3
    v_xor_b32 v32, 2, v2
    v_lshl_add_u32 v32, v32, 4, v3
    v_xor_b32 v33, 4, v2
    v_lshl_add_u32 v33, v33, 4, v3
    v_xor_b32 v34, 6, v2
    v_lshl_add_u32 v34, v34, 4, v3
    s_lshl_b32 s31, s90, 12
    s_lshl_b32 s32, s91, 12
    s_add_u32 s32, s32, 8192
    v_add_u32 v35, s32, v31
    v_add_u32 v31, s31, v31
    v_add_u32 v36, s32, v32
    v_add_u32 v32, s31, v32
    v_add_u32 v37, s32, v33
    v_add_u32 v33, s31, v33
    v_add_u32 v38, s32, v34
    v_add_u32 v34, s31, v34
    v_lshrrev_b32 v30, 5, v1
    v_lshlrev_b32 v30, 3, v30
    v_bfe_u32 v2, v1, 2, 2
    v_add_u32 v30, v30, v2
    v_lshlrev_b32 v30, 7, v30
    v_bfe_u32 v2, v1, 3, 1
    v_xor_b32 v2, s91, v2
    v_lshl_add_u32 v30, v2, 6, v30
    v_bfe_u32 v2, v1, 4, 1
    v_lshl_add_u32 v30, v2, 5, v30
    v_bfe_u32 v2, v1, 1, 1
    v_lshl_add_u32 v30, v2, 4, v30
    v_and_b32 v2, 1, v1
    v_lshl_add_u32 v30, v2, 3, v30
    v_add_u32 v30, 0x2000, v30
    v_lshrrev_b32 v29, 5, v1
    v_lshlrev_b32 v29, 3, v29
    v_bfe_u32 v2, v1, 2, 2
    v_add_u32 v29, v29, v2
    v_lshlrev_b32 v29, 7, v29
    v_bfe_u32 v2, v1, 3, 1
    v_xor_b32 v2, s90, v2
    v_lshl_add_u32 v29, v2, 6, v29
    v_bfe_u32 v2, v1, 4, 1
    v_lshl_add_u32 v29, v2, 5, v29
    v_bfe_u32 v2, v1, 1, 1
    v_lshl_add_u32 v29, v2, 4, v29
    v_and_b32 v2, 1, v1
    v_lshl_add_u32 v29, v2, 3, v29
    v_mov_b32 v228, v31
    v_mov_b32 v229, v32
    v_mov_b32 v230, v33
    v_mov_b32 v231, v34
    v_mov_b32 v232, v35
    v_mov_b32 v233, v36
    v_mov_b32 v234, v37
    v_mov_b32 v235, v38
    v_mov_b32 v236, v30
    v_mov_b32 v237, v29
    s_mov_b32 s75, 16384
    v_lshrrev_b32 v104, 5, v1
    v_lshlrev_b32 v104, 3, v104
    s_cmp_ge_u32 s38, 28
    s_cbranch_scc1 C_ATT0
    v_mov_b32 v148, 0
    v_mov_b32 v149, 0
    v_mov_b32 v150, 0
    v_mov_b32 v151, 0
    v_mov_b32 v152, 0
    v_mov_b32 v153, 0
    v_mov_b32 v154, 0
    v_mov_b32 v155, 0
    v_mov_b32 v156, 0
    v_mov_b32 v157, 0
    v_mov_b32 v158, 0
    v_mov_b32 v159, 0
    v_mov_b32 v160, 0
    v_mov_b32 v161, 0
    v_mov_b32 v162, 0
    v_mov_b32 v163, 0
    s_lshl_b32 s93, s36, 7
    s_lshl_b32 s31, s90, 6
    s_add_u32 s93, s93, s31
    buffer_load_dwordx2 v[124:125], v104, s[48:51], s93 offen offset:0
    buffer_load_dwordx2 v[126:127], v104, s[48:51], s93 offen offset:16
    buffer_load_dwordx2 v[128:129], v104, s[48:51], s93 offen offset:32
    buffer_load_dwordx2 v[130:131], v104, s[48:51], s93 offen offset:48
    s_mov_b32 s88, 49152
    v_add_u32 v29, s88, v29
    v_add_u32 v30, s88, v30
    s_barrier
    ds_read_b64_tr_b16 v[164:165], v29 offset:0
    ds_read_b64_tr_b16 v[168:169], v30 offset:0
    ds_read_b64_tr_b16 v[166:167], v29 offset:512
    ds_read_b64_tr_b16 v[170:171], v30 offset:512
    ds_read_b64_tr_b16 v[172:173], v29 offset:2048
    ds_read_b64_tr_b16 v[176:177], v30 offset:2048
    ds_read_b64_tr_b16 v[174:175], v29 offset:2560
    ds_read_b64_tr_b16 v[178:179], v30 offset:2560
    ds_read_b64_tr_b16 v[180:181], v29 offset:4096
    ds_read_b64_tr_b16 v[184:185], v30 offset:4096
    ds_read_b64_tr_b16 v[182:183], v29 offset:4608
    ds_read_b64_tr_b16 v[186:187], v30 offset:4608
    ds_read_b64_tr_b16 v[188:189], v29 offset:6144
    ds_read_b64_tr_b16 v[192:193], v30 offset:6144
    ds_read_b64_tr_b16 v[190:191], v29 offset:6656
    ds_read_b64_tr_b16 v[194:195], v30 offset:6656
    s_cmp_eq_u32 s29, 0
    s_cselect_b32 s92, 0, 2
    s_and_b32 s72, s2, 7
    s_lshl_b32 s72, s72, 10
    s_mov_b32 s39, 0
C_P2a:
    s_barrier
    s_add_u32 s88, s88, 16384
    s_cmp_eq_u32 s88, 147456
    s_cselect_b32 s89, 0xfffe0000, s75
    s_cselect_b32 s88, 0, s88
    v_add_u32 v29, s89, v29
    v_add_u32 v30, s89, v30
    s_waitcnt lgkmcnt(12)
    v_mfma_f32_32x32x16_bf16 v[148:163], v[164:167], v[168:171], v[148:163]
    ds_read_b64_tr_b16 v[196:197], v29 offset:0
    ds_read_b64_tr_b16 v[200:201], v30 offset:0
    ds_read_b64_tr_b16 v[198:199], v29 offset:512
    ds_read_b64_tr_b16 v[202:203], v30 offset:512
    s_waitcnt lgkmcnt(12)
    v_mfma_f32_32x32x16_bf16 v[148:163], v[172:175], v[176:179], v[148:163]
    ds_read_b64_tr_b16 v[204:205], v29 offset:2048
    ds_read_b64_tr_b16 v[208:209], v30 offset:2048
    ds_read_b64_tr_b16 v[206:207], v29 offset:2560
    ds_read_b64_tr_b16 v[210:211], v30 offset:2560
    s_waitcnt lgkmcnt(12)
    v_mfma_f32_32x32x16_bf16 v[148:163], v[180:183], v[184:187], v[148:163]
    ds_read_b64_tr_b16 v[212:213], v29 offset:4096
    ds_read_b64_tr_b16 v[216:217], v30 offset:4096
    ds_read_b64_tr_b16 v[214:215], v29 offset:4608
    ds_read_b64_tr_b16 v[218:219], v30 offset:4608
    s_waitcnt lgkmcnt(12)
    v_mfma_f32_32x32x16_bf16 v[148:163], v[188:191], v[192:195], v[148:163]
    ds_read_b64_tr_b16 v[220:221], v29 offset:6144
    ds_read_b64_tr_b16 v[224:225], v30 offset:6144
    ds_read_b64_tr_b16 v[222:223], v29 offset:6656
    ds_read_b64_tr_b16 v[226:227], v30 offset:6656
    s_cmp_eq_u32 s92, 2
    s_cbranch_scc1 C_PH_X
    s_cmp_eq_u32 s92, 1
    s_cbranch_scc1 C_PH_E
    buffer_load_dwordx4 v[120:123], v4, s[44:47], s72 offen sc1
    s_mov_b32 s92, 1
    s_branch C_PH_X
C_PH_E:
    s_getreg_b32 s31, hwreg(HW_REG_IB_STS)
    s_and_b32 s31, s31, 0xc0000f
    s_cbranch_scc1 C_PH_X
    s_mov_b32 s92, 0
    v_xor_b32 v120, s40, v120
    v_xor_b32 v121, s40, v121
    v_or_b32 v120, v120, v121
    v_xor_b32 v122, s40, v122
    v_or_b32 v120, v120, v122
    v_xor_b32 v123, s40, v123
    v_or_b32 v120, v120, v123
    v_cmp_ne_u32 vcc, 0, v120
    s_cmp_lg_u64 vcc, 0
    s_cbranch_scc1 C_PH_X
    v_mov_b32 v2, 147484
    v_mov_b32 v3, s40
    ds_write_b32 v2, v3
    s_mov_b32 s92, 2
C_PH_X:
    s_barrier
    s_add_u32 s88, s88, 16384
    s_cmp_eq_u32 s88, 147456
    s_cselect_b32 s89, 0xfffe0000, s75
    s_cselect_b32 s88, 0, s88
    v_add_u32 v29, s89, v29
    v_add_u32 v30, s89, v30
    s_waitcnt lgkmcnt(12)
    v_mfma_f32_32x32x16_bf16 v[148:163], v[196:199], v[200:203], v[148:163]
    ds_read_b64_tr_b16 v[164:165], v29 offset:0
    ds_read_b64_tr_b16 v[168:169], v30 offset:0
    ds_read_b64_tr_b16 v[166:167], v29 offset:512
    ds_read_b64_tr_b16 v[170:171], v30 offset:512
    s_waitcnt lgkmcnt(12)
    v_mfma_f32_32x32x16_bf16 v[148:163], v[204:207], v[208:211], v[148:163]
    ds_read_b64_tr_b16 v[172:173], v29 offset:2048
    ds_read_b64_tr_b16 v[176:177], v30 offset:2048
    ds_read_b64_tr_b16 v[174:175], v29 offset:2560
    ds_read_b64_tr_b16 v[178:179], v30 offset:2560
    s_waitcnt lgkmcnt(12)
    v_mfma_f32_32x32x16_bf16 v[148:163], v[212:215], v[216:219], v[148:163]
    ds_read_b64_tr_b16 v[180:181], v29 offset:4096
    ds_read_b64_tr_b16 v[184:185], v30 offset:4096
    ds_read_b64_tr_b16 v[182:183], v29 offset:4608
    ds_read_b64_tr_b16 v[186:187], v30 offset:4608
    s_waitcnt lgkmcnt(12)
    v_mfma_f32_32x32x16_bf16 v[148:163], v[220:223], v[224:227], v[148:163]
    ds_read_b64_tr_b16 v[188:189], v29 offset:6144
    ds_read_b64_tr_b16 v[192:193], v30 offset:6144
    ds_read_b64_tr_b16 v[190:191], v29 offset:6656
    ds_read_b64_tr_b16 v[194:195], v30 offset:6656
    s_add_u32 s39, s39, 2
    s_cmp_lt_u32 s39, 6
    s_cbranch_scc1 C_P2a
    s_mov_b32 s39, 0
C_PHB:
    s_cmp_eq_u32 s92, 2
    s_cbranch_scc1 C_PHB_X
    buffer_load_dwordx4 v[120:123], v4, s[44:47], s72 offen sc1
    s_waitcnt vmcnt(0)
    s_add_u32 s39, s39, 1
    s_cmp_ge_u32 s39, 0x4000
    s_cbranch_scc1 C_PHB_X
    s_mov_b32 s92, 0
    v_xor_b32 v120, s40, v120
    v_xor_b32 v121, s40, v121
    v_or_b32 v120, v120, v121
    v_xor_b32 v122, s40, v122
    v_or_b32 v120, v120, v122
    v_xor_b32 v123, s40, v123
    v_or_b32 v120, v120, v123
    v_cmp_ne_u32 vcc, 0, v120
    s_cmp_lg_u64 vcc, 0
    s_cbranch_scc1 C_PHB
    v_mov_b32 v2, 147484
    v_mov_b32 v3, s40
    ds_write_b32 v2, v3
    s_mov_b32 s92, 2
C_PHB_X:
    s_mov_b32 s39, 0
C_P2:
    s_barrier
    s_add_u32 s88, s88, 16384
    s_cmp_eq_u32 s88, 147456
    s_cselect_b32 s89, 0xfffe0000, s75
    s_cselect_b32 s88, 0, s88
    v_add_u32 v29, s89, v29
    v_add_u32 v30, s89, v30
    s_waitcnt lgkmcnt(12)
    v_mfma_f32_32x32x16_bf16 v[148:163], v[164:167], v[168:171], v[148:163]
    ds_read_b64_tr_b16 v[196:197], v29 offset:0
    ds_read_b64_tr_b16 v[200:201], v30 offset:0
    ds_read_b64_tr_b16 v[198:199], v29 offset:512
    ds_read_b64_tr_b16 v[202:203], v30 offset:512
    s_waitcnt lgkmcnt(12)
    v_mfma_f32_32x32x16_bf16 v[148:163], v[172:175], v[176:179], v[148:163]
    ds_read_b64_tr_b16 v[204:205], v29 offset:2048
    ds_read_b64_tr_b16 v[208:209], v30 offset:2048
    ds_read_b64_tr_b16 v[206:207], v29 offset:2560
    ds_read_b64_tr_b16 v[210:211], v30 offset:2560
    s_waitcnt lgkmcnt(12)
    v_mfma_f32_32x32x16_bf16 v[148:163], v[180:183], v[184:187], v[148:163]
    ds_read_b64_tr_b16 v[212:213], v29 offset:4096
    ds_read_b64_tr_b16 v[216:217], v30 offset:4096
    ds_read_b64_tr_b16 v[214:215], v29 offset:4608
    ds_read_b64_tr_b16 v[218:219], v30 offset:4608
    s_waitcnt lgkmcnt(12)
    v_mfma_f32_32x32x16_bf16 v[148:163], v[188:191], v[192:195], v[148:163]
    ds_read_b64_tr_b16 v[220:221], v29 offset:6144
    ds_read_b64_tr_b16 v[224:225], v30 offset:6144
    ds_read_b64_tr_b16 v[222:223], v29 offset:6656
    ds_read_b64_tr_b16 v[226:227], v30 offset:6656
    s_barrier
    s_add_u32 s88, s88, 16384
    s_cmp_eq_u32 s88, 147456
    s_cselect_b32 s89, 0xfffe0000, s75
    s_cselect_b32 s88, 0, s88
    v_add_u32 v29, s89, v29
    v_add_u32 v30, s89, v30
    s_waitcnt lgkmcnt(12)
    v_mfma_f32_32x32x16_bf16 v[148:163], v[196:199], v[200:203], v[148:163]
    ds_read_b64_tr_b16 v[164:165], v29 offset:0
    ds_read_b64_tr_b16 v[168:169], v30 offset:0
    ds_read_b64_tr_b16 v[166:167], v29 offset:512
    ds_read_b64_tr_b16 v[170:171], v30 offset:512
    s_waitcnt lgkmcnt(12)
    v_mfma_f32_32x32x16_bf16 v[148:163], v[204:207], v[208:211], v[148:163]
    ds_read_b64_tr_b16 v[172:173], v29 offset:2048
    ds_read_b64_tr_b16 v[176:177], v30 offset:2048
    ds_read_b64_tr_b16 v[174:175], v29 offset:2560
    ds_read_b64_tr_b16 v[178:179], v30 offset:2560
    s_waitcnt lgkmcnt(12)
    v_mfma_f32_32x32x16_bf16 v[148:163], v[212:215], v[216:219], v[148:163]
    ds_read_b64_tr_b16 v[180:181], v29 offset:4096
    ds_read_b64_tr_b16 v[184:185], v30 offset:4096
    ds_read_b64_tr_b16 v[182:183], v29 offset:4608
    ds_read_b64_tr_b16 v[186:187], v30 offset:4608
    s_waitcnt lgkmcnt(12)
    v_mfma_f32_32x32x16_bf16 v[148:163], v[220:223], v[224:227], v[148:163]
    ds_read_b64_tr_b16 v[188:189], v29 offset:6144
    ds_read_b64_tr_b16 v[192:193], v30 offset:6144
    ds_read_b64_tr_b16 v[190:191], v29 offset:6656
    ds_read_b64_tr_b16 v[194:195], v30 offset:6656
    s_add_u32 s39, s39, 2
    s_cmp_lt_u32 s39, 24
    s_cbranch_scc1 C_P2
    s_barrier
    s_add_u32 s88, s88, 16384
    s_cmp_eq_u32 s88, 147456
    s_cselect_b32 s89, 0xfffe0000, s75
    s_cselect_b32 s88, 0, s88
    v_add_u32 v29, s89, v29
    v_add_u32 v30, s89, v30
    s_waitcnt lgkmcnt(12)
    v_mfma_f32_32x32x16_bf16 v[148:163], v[164:167], v[168:171], v[148:163]
    ds_read_b64_tr_b16 v[196:197], v29 offset:0
    ds_read_b64_tr_b16 v[200:201], v30 offset:0
    ds_read_b64_tr_b16 v[198:199], v29 offset:512
    ds_read_b64_tr_b16 v[202:203], v30 offset:512
    s_waitcnt lgkmcnt(12)
    v_mfma_f32_32x32x16_bf16 v[148:163], v[172:175], v[176:179], v[148:163]
    ds_read_b64_tr_b16 v[204:205], v29 offset:2048
    ds_read_b64_tr_b16 v[208:209], v30 offset:2048
    ds_read_b64_tr_b16 v[206:207], v29 offset:2560
    ds_read_b64_tr_b16 v[210:211], v30 offset:2560
    s_waitcnt lgkmcnt(12)
    v_mfma_f32_32x32x16_bf16 v[148:163], v[180:183], v[184:187], v[148:163]
    ds_read_b64_tr_b16 v[212:213], v29 offset:4096
    ds_read_b64_tr_b16 v[216:217], v30 offset:4096
    ds_read_b64_tr_b16 v[214:215], v29 offset:4608
    ds_read_b64_tr_b16 v[218:219], v30 offset:4608
    s_waitcnt lgkmcnt(12)
    v_mfma_f32_32x32x16_bf16 v[148:163], v[188:191], v[192:195], v[148:163]
    ds_read_b64_tr_b16 v[220:221], v29 offset:6144
    ds_read_b64_tr_b16 v[224:225], v30 offset:6144
    ds_read_b64_tr_b16 v[222:223], v29 offset:6656
    ds_read_b64_tr_b16 v[226:227], v30 offset:6656
    s_waitcnt lgkmcnt(12)
    v_mfma_f32_32x32x16_bf16 v[148:163], v[196:199], v[200:203], v[148:163]
    s_waitcnt lgkmcnt(8)
    v_mfma_f32_32x32x16_bf16 v[148:163], v[204:207], v[208:211], v[148:163]
    s_waitcnt lgkmcnt(4)
    v_mfma_f32_32x32x16_bf16 v[148:163], v[212:215], v[216:219], v[148:163]
    s_waitcnt lgkmcnt(0)
    v_mfma_f32_32x32x16_bf16 v[148:163], v[220:223], v[224:227], v[148:163]
    s_waitcnt vmcnt(0)
    s_nop 7
    s_nop 7
    v_cvt_pk_bf16_f32 v180, v148, v149
    v_cvt_pk_bf16_f32 v181, v150, v151
    v_cvt_pk_bf16_f32 v182, v152, v153
    v_cvt_pk_bf16_f32 v183, v154, v155
    v_cvt_pk_bf16_f32 v184, v156, v157
    v_cvt_pk_bf16_f32 v185, v158, v159
    v_cvt_pk_bf16_f32 v186, v160, v161
    v_cvt_pk_bf16_f32 v187, v162, v163
    v_mov_b32 v148, 0
    v_mov_b32 v149, 0
    v_mov_b32 v150, 0
    v_mov_b32 v151, 0
    v_mov_b32 v152, 0
    v_mov_b32 v153, 0
    v_mov_b32 v154, 0
    v_mov_b32 v155, 0
    v_mov_b32 v156, 0
    v_mov_b32 v157, 0
    v_mov_b32 v158, 0
    v_mov_b32 v159, 0
    v_mov_b32 v160, 0
    v_mov_b32 v161, 0
    v_mov_b32 v162, 0
    v_mov_b32 v163, 0
    v_lshlrev_b32 v164, 16, v180
    v_and_b32 v165, 0xffff0000, v180
    v_lshlrev_b32 v166, 16, v181
    v_and_b32 v167, 0xffff0000, v181
    v_lshlrev_b32 v168, 16, v182
    v_and_b32 v169, 0xffff0000, v182
    v_lshlrev_b32 v170, 16, v183
    v_and_b32 v171, 0xffff0000, v183
    v_lshlrev_b32 v172, 16, v184
    v_and_b32 v173, 0xffff0000, v184
    v_lshlrev_b32 v174, 16, v185
    v_and_b32 v175, 0xffff0000, v185
    v_lshlrev_b32 v176, 16, v186
    v_and_b32 v177, 0xffff0000, v186
    v_lshlrev_b32 v178, 16, v187
    v_and_b32 v179, 0xffff0000, v187
    v_lshlrev_b32 v180, 16, v124
    v_and_b32 v181, 0xffff0000, v124
    v_lshlrev_b32 v182, 16, v125
    v_and_b32 v183, 0xffff0000, v125
    v_lshlrev_b32 v184, 16, v126
    v_and_b32 v185, 0xffff0000, v126
    v_lshlrev_b32 v186, 16, v127
    v_and_b32 v187, 0xffff0000, v127
    v_lshlrev_b32 v188, 16, v128
    v_and_b32 v189, 0xffff0000, v128
    v_lshlrev_b32 v190, 16, v129
    v_and_b32 v191, 0xffff0000, v129
    v_lshlrev_b32 v192, 16, v130
    v_and_b32 v193, 0xffff0000, v130
    v_lshlrev_b32 v194, 16, v131
    v_and_b32 v195, 0xffff0000, v131
    v_pk_add_f32 v[164:165], v[164:165], v[180:181]
    v_pk_add_f32 v[166:167], v[166:167], v[182:183]
    v_pk_add_f32 v[168:169], v[168:169], v[184:185]
    v_pk_add_f32 v[170:171], v[170:171], v[186:187]
    v_pk_add_f32 v[172:173], v[172:173], v[188:189]
    v_pk_add_f32 v[174:175], v[174:175], v[190:191]
    v_pk_add_f32 v[176:177], v[176:177], v[192:193]
    v_pk_add_f32 v[178:179], v[178:179], v[194:195]
    v_cvt_pk_bf16_f32 v180, v164, v165
    v_cvt_pk_bf16_f32 v181, v166, v167
    v_cvt_pk_bf16_f32 v182, v168, v169
    v_cvt_pk_bf16_f32 v183, v170, v171
    v_cvt_pk_bf16_f32 v184, v172, v173
    v_cvt_pk_bf16_f32 v185, v174, v175
    v_cvt_pk_bf16_f32 v186, v176, v177
    v_cvt_pk_bf16_f32 v187, v178, v179
    v_lshlrev_b32 v164, 16, v180
    v_and_b32 v165, 0xffff0000, v180
    v_lshlrev_b32 v166, 16, v181
    v_and_b32 v167, 0xffff0000, v181
    v_lshlrev_b32 v168, 16, v182
    v_and_b32 v169, 0xffff0000, v182
    v_lshlrev_b32 v170, 16, v183
    v_and_b32 v171, 0xffff0000, v183
    v_lshlrev_b32 v172, 16, v184
    v_and_b32 v173, 0xffff0000, v184
    v_lshlrev_b32 v174, 16, v185
    v_and_b32 v175, 0xffff0000, v185
    v_lshlrev_b32 v176, 16, v186
    v_and_b32 v177, 0xffff0000, v186
    v_lshlrev_b32 v178, 16, v187
    v_and_b32 v179, 0xffff0000, v187
    v_mov_b32 v204, 0xbdd2d3e8
    v_mov_b32 v205, 0xbdd2d3e8
    v_mov_b32 v206, 0xc0135761
    v_mov_b32 v207, 0xc0135761
    v_pk_mul_f32 v[180:181], v[164:165], v[164:165]
    v_pk_mul_f32 v[182:183], v[166:167], v[166:167]
    v_pk_mul_f32 v[184:185], v[168:169], v[168:169]
    v_pk_mul_f32 v[186:187], v[170:171], v[170:171]
    v_pk_mul_f32 v[188:189], v[172:173], v[172:173]
    v_pk_mul_f32 v[190:191], v[174:175], v[174:175]
    v_pk_mul_f32 v[192:193], v[176:177], v[176:177]
    v_pk_mul_f32 v[194:195], v[178:179], v[178:179]
    v_pk_fma_f32 v[180:181], v[180:181], v[204:205], v[206:207]
    v_pk_fma_f32 v[182:183], v[182:183], v[204:205], v[206:207]
    v_pk_fma_f32 v[184:185], v[184:185], v[204:205], v[206:207]
    v_pk_fma_f32 v[186:187], v[186:187], v[204:205], v[206:207]
    v_pk_fma_f32 v[188:189], v[188:189], v[204:205], v[206:207]
    v_pk_fma_f32 v[190:191], v[190:191], v[204:205], v[206:207]
    v_pk_fma_f32 v[192:193], v[192:193], v[204:205], v[206:207]
    v_pk_fma_f32 v[194:195], v[194:195], v[204:205], v[206:207]
    v_pk_mul_f32 v[180:181], v[180:181], v[164:165]
    v_pk_mul_f32 v[182:183], v[182:183], v[166:167]
    v_pk_mul_f32 v[184:185], v[184:185], v[168:169]
    v_pk_mul_f32 v[186:187], v[186:187], v[170:171]
    v_pk_mul_f32 v[188:189], v[188:189], v[172:173]
    v_pk_mul_f32 v[190:191], v[190:191], v[174:175]
    v_pk_mul_f32 v[192:193], v[192:193], v[176:177]
    v_pk_mul_f32 v[194:195], v[194:195], v[178:179]
    v_exp_f32 v180, v180
    v_exp_f32 v181, v181
    v_exp_f32 v182, v182
    v_exp_f32 v183, v183
    v_exp_f32 v184, v184
    v_exp_f32 v185, v185
    v_exp_f32 v186, v186
    v_exp_f32 v187, v187
    v_exp_f32 v188, v188
    v_exp_f32 v189, v189
    v_exp_f32 v190, v190
    v_exp_f32 v191, v191
    v_exp_f32 v192, v192
    v_exp_f32 v193, v193
    v_exp_f32 v194, v194
    v_exp_f32 v195, v195
    s_nop 0
    v_add_f32 v180, 1.0, v180
    v_add_f32 v181, 1.0, v181
    v_add_f32 v182, 1.0, v182
    v_add_f32 v183, 1.0, v183
    v_add_f32 v184, 1.0, v184
    v_add_f32 v185, 1.0, v185
    v_add_f32 v186, 1.0, v186
    v_add_f32 v187, 1.0, v187
    v_add_f32 v188, 1.0, v188
    v_add_f32 v189, 1.0, v189
    v_add_f32 v190, 1.0, v190
    v_add_f32 v191, 1.0, v191
    v_add_f32 v192, 1.0, v192
    v_add_f32 v193, 1.0, v193
    v_add_f32 v194, 1.0, v194
    v_add_f32 v195, 1.0, v195
    v_rcp_f32 v180, v180
    v_rcp_f32 v181, v181
    v_rcp_f32 v182, v182
    v_rcp_f32 v183, v183
    v_rcp_f32 v184, v184
    v_rcp_f32 v185, v185
    v_rcp_f32 v186, v186
    v_rcp_f32 v187, v187
    v_rcp_f32 v188, v188
    v_rcp_f32 v189, v189
    v_rcp_f32 v190, v190
    v_rcp_f32 v191, v191
    v_rcp_f32 v192, v192
    v_rcp_f32 v193, v193
    v_rcp_f32 v194, v194
    v_rcp_f32 v195, v195
    s_nop 0
    v_pk_mul_f32 v[164:165], v[164:165], v[180:181]
    v_pk_mul_f32 v[166:167], v[166:167], v[182:183]
    v_pk_mul_f32 v[168:169], v[168:169], v[184:185]
    v_pk_mul_f32 v[170:171], v[170:171], v[186:187]
    v_pk_mul_f32 v[172:173], v[172:173], v[188:189]
    v_pk_mul_f32 v[174:175], v[174:175], v[190:191]
    v_pk_mul_f32 v[176:177], v[176:177], v[192:193]
    v_pk_mul_f32 v[178:179], v[178:179], v[194:195]
    v_cvt_pk_bf16_f32 v196, v164, v165
    v_cvt_pk_bf16_f32 v197, v166, v167
    v_cvt_pk_bf16_f32 v198, v168, v169
    v_cvt_pk_bf16_f32 v199, v170, v171
    v_cvt_pk_bf16_f32 v200, v172, v173
    v_cvt_pk_bf16_f32 v201, v174, v175
    v_cvt_pk_bf16_f32 v202, v176, v177
    v_cvt_pk_bf16_f32 v203, v178, v179
    v_and_b32 v2, 31, v1
    s_lshl_b32 s31, s91, 5
    v_add_u32 v2, s31, v2
    v_mul_u32_u24 v2, 144, v2
    v_add_u32 v2, v2, v104
    s_lshl_b32 s31, s90, 6
    s_add_u32 s31, s31, 0x24040
    v_add_u32 v2, s31, v2
    ds_write_b64 v2, v[196:197] offset:0
    ds_write_b64 v2, v[198:199] offset:16
    ds_write_b64 v2, v[200:201] offset:32
    ds_write_b64 v2, v[202:203] offset:48
    v_lshrrev_b32 v2, 3, v1
    s_lshl_b32 s31, s29, 4
    v_add_u32 v2, s31, v2
    v_mul_u32_u24 v116, 144, v2
    v_and_b32 v3, 7, v1
    v_lshl_add_u32 v116, v3, 4, v116
    v_add_u32 v116, 0x24040, v116
    s_movk_i32 s31, 3584
    v_mul_lo_u32 v117, v2, s31
    v_lshl_add_u32 v117, v3, 4, v117
    s_waitcnt lgkmcnt(0)
    s_barrier
    ds_read_b128 v[108:111], v116
    ds_read_b128 v[112:115], v116 offset:1152
    s_mul_i32 s31, s35, 229376
    s_lshl_b32 s32, s36, 7
    s_add_u32 s31, s31, s32
    s_add_u32 s32, s31, 28672
    s_waitcnt lgkmcnt(1)
    buffer_store_dwordx4 v[108:111], v117, s[52:55], s31 offen sc1
    s_waitcnt lgkmcnt(0)
    buffer_store_dwordx4 v[112:115], v117, s[52:55], s32 offen sc1
    v_lshrrev_b32 v28, 2, v1
    v_lshlrev_b32 v28, 5, v28
    v_and_b32 v2, 3, v1
    v_lshl_add_u32 v28, v2, 1, v28
    s_and_b32 s31, s35, 3
    s_lshl_b32 s31, s31, 3
    s_lshr_b32 s32, s35, 2
    s_add_u32 s31, s31, s32
    v_add_u32 v28, s31, v28
    v_lshlrev_b32 v28, 7, v28
    s_mov_b32 s87, -1
    s_lshl_b32 s31, s36, 2
    s_add_u32 s31, s31, 8192
    s_mov_b32 s86, s31
    s_mov_b32 s85, 147468
    s_mov_b32 s76, 0
    s_branch C_ATT
C_ATT0:
    s_barrier
C_ATT:
    v_lshrrev_b32 v29, 5, v1
    v_lshlrev_b32 v29, 3, v29
    v_bfe_u32 v2, v1, 2, 2
    v_add_u32 v29, v29, v2
    v_lshlrev_b32 v29, 7, v29
    v_bfe_u32 v2, v1, 3, 1
    v_xor_b32 v2, 0, v2
    v_lshl_add_u32 v29, v2, 6, v29
    v_bfe_u32 v2, v1, 4, 1
    v_lshl_add_u32 v29, v2, 5, v29
    v_bfe_u32 v2, v1, 1, 1
    v_lshl_add_u32 v29, v2, 4, v29
    v_and_b32 v2, 1, v1
    v_lshl_add_u32 v29, v2, 3, v29
    v_lshrrev_b32 v30, 5, v1
    v_lshlrev_b32 v30, 3, v30
    v_bfe_u32 v2, v1, 2, 2
    v_add_u32 v30, v30, v2
    v_lshlrev_b32 v30, 7, v30
    v_bfe_u32 v2, v1, 3, 1
    v_xor_b32 v2, 1, v2
    v_lshl_add_u32 v30, v2, 6, v30
    v_bfe_u32 v2, v1, 4, 1
    v_lshl_add_u32 v30, v2, 5, v30
    v_bfe_u32 v2, v1, 1, 1
    v_lshl_add_u32 v30, v2, 4, v30
    v_and_b32 v2, 1, v1
    v_lshl_add_u32 v30, v2, 3, v30
    s_add_u32 s31, s29, 1
    s_cmp_eq_u32 s29, 2
    s_cselect_b32 s31, 0, s31
    s_cmp_eq_u32 s29, 3
    s_cselect_b32 s31, 1, s31
    s_cselect_b32 s32, 0, 4096
    s_lshl_b32 s31, s31, 13
    s_add_u32 s31, s31, 12288
    v_add_u32 v29, s31, v29
    v_add_u32 v30, s31, v30
    v_bfe_u32 v2, v1, 1, 3
    v_lshrrev_b32 v3, 5, v1
    v_xor_b32 v2, v2, v3
    v_and_b32 v3, 31, v1
    v_lshlrev_b32 v3, 7, v3
    v_xor_b32 v31, 0, v2
    v_lshl_add_u32 v31, v31, 4, v3
    v_xor_b32 v32, 2, v2
    v_lshl_add_u32 v32, v32, 4, v3
    v_xor_b32 v33, 4, v2
    v_lshl_add_u32 v33, v33, 4, v3
    v_xor_b32 v34, 6, v2
    v_lshl_add_u32 v34, v34, 4, v3
    v_add_u32 v31, s32, v31
    v_add_u32 v32, s32, v32
    v_add_u32 v33, s32, v33
    v_add_u32 v34, s32, v34
    s_mov_b32 s88, 0
    s_mov_b32 s39, 5
    s_mov_b32 s74, 7
    s_cmp_eq_u32 s85, 0
    s_cbranch_scc1 C_SUp_S
C_SUp_R:
    s_getreg_b32 s31, hwreg(HW_REG_IB_STS)
    s_lshr_b32 s32, s31, 18
    s_and_b32 s32, s32, 0x30
    s_and_b32 s31, s31, 15
    s_or_b32 s31, s31, s32
    s_cmp_gt_u32 s31, s76
    s_cbranch_scc1 C_SUp_S
    v_mov_b32 v2, s85
    v_mov_b32 v3, 1
    s_mov_b32 s85, 0
    s_mov_b64 exec, 1
    ds_add_rtn_u32 v3, v2, v3
    s_waitcnt lgkmcnt(0)
    v_readfirstlane_b32 s31, v3
    s_cmp_lg_u32 s31, 3
    s_cbranch_scc1 C_SUp_N
    s_mov_b32 exec_lo, s87
    v_mov_b32 v3, s40
    buffer_store_dword v3, v28, s[44:47], s86 offen sc1
C_SUp_N:
    s_mov_b64 exec, -1
C_SUp_S:
    s_barrier
    s_branch C_P1_ENTER
C_P1B_DONE:
    s_barrier
    v_and_b32 v2, 31, v1
    v_mul_u32_u24 v2, 400, v2
    v_lshrrev_b32 v3, 5, v1
    v_lshl_add_u32 v2, v3, 3, v2
    s_add_u32 s89, s29, 1
    s_cmp_eq_u32 s29, 2
    s_cselect_b32 s89, 0, s89
    s_lshl_b32 s89, s89, 7
    s_add_u32 s89, s89, 121856
    s_cmp_eq_u32 s29, 3
    s_cselect_b32 s89, 109184, s89
    v_add_u32 v124, s89, v2
    s_cselect_b32 s89, 64, 12800
    s_cselect_b32 s88, 128, 64
    s_nop 1
    v_cvt_pk_bf16_f32 v126, v40, v41
    v_cvt_pk_bf16_f32 v127, v42, v43
    ds_write_b64 v124, v[126:127] offset:0
    v_cvt_pk_bf16_f32 v128, v44, v45
    v_cvt_pk_bf16_f32 v129, v46, v47
    ds_write_b64 v124, v[128:129] offset:16
    v_cvt_pk_bf16_f32 v130, v48, v49
    v_cvt_pk_bf16_f32 v131, v50, v51
    ds_write_b64 v124, v[130:131] offset:32
    v_cvt_pk_bf16_f32 v132, v52, v53
    v_cvt_pk_bf16_f32 v133, v54, v55
    ds_write_b64 v124, v[132:133] offset:48
    v_add_u32 v125, s89, v124
    v_cvt_pk_bf16_f32 v134, v56, v57
    v_cvt_pk_bf16_f32 v135, v58, v59
    ds_write_b64 v125, v[134:135] offset:0
    v_cvt_pk_bf16_f32 v136, v60, v61
    v_cvt_pk_bf16_f32 v137, v62, v63
    ds_write_b64 v125, v[136:137] offset:16
    v_cvt_pk_bf16_f32 v138, v64, v65
    v_cvt_pk_bf16_f32 v139, v66, v67
    ds_write_b64 v125, v[138:139] offset:32
    v_cvt_pk_bf16_f32 v140, v68, v69
    v_cvt_pk_bf16_f32 v141, v70, v71
    ds_write_b64 v125, v[140:141] offset:48
    v_add_u32 v125, s88, v124
    v_cvt_pk_bf16_f32 v126, v72, v73
    v_cvt_pk_bf16_f32 v127, v74, v75
    ds_write_b64 v125, v[126:127] offset:0
    v_cvt_pk_bf16_f32 v128, v76, v77
    v_cvt_pk_bf16_f32 v129, v78, v79
    ds_write_b64 v125, v[128:129] offset:16
    v_cvt_pk_bf16_f32 v130, v80, v81
    v_cvt_pk_bf16_f32 v131, v82, v83
    ds_write_b64 v125, v[130:131] offset:32
    v_cvt_pk_bf16_f32 v132, v84, v85
    v_cvt_pk_bf16_f32 v133, v86, v87
    ds_write_b64 v125, v[132:133] offset:48
    v_add_u32 v125, s89, v125
    v_cvt_pk_bf16_f32 v134, v88, v89
    v_cvt_pk_bf16_f32 v135, v90, v91
    ds_write_b64 v125, v[134:135] offset:0
    v_cvt_pk_bf16_f32 v136, v92, v93
    v_cvt_pk_bf16_f32 v137, v94, v95
    ds_write_b64 v125, v[136:137] offset:16
    v_cvt_pk_bf16_f32 v138, v96, v97
    v_cvt_pk_bf16_f32 v139, v98, v99
    ds_write_b64 v125, v[138:139] offset:32
    v_cvt_pk_bf16_f32 v140, v100, v101
    v_cvt_pk_bf16_f32 v141, v102, v103
    ds_write_b64 v125, v[140:141] offset:48
    s_waitcnt lgkmcnt(0)
    s_barrier
    v_lshrrev_b32 v197, 2, v1
    s_lshl_b32 s31, s29, 4
    v_add_u32 v197, s31, v197
    v_add_u32 v196, 18, v197
    v_mul_u32_u24 v196, 400, v196
    v_and_b32 v2, 3, v1
    v_lshl_add_u32 v196, v2, 5, v196
    v_add_u32 v196, 0x1aa00, v196
    ds_read_b128 v[124:127], v196 offset:5600
    ds_read_b128 v[128:131], v196 offset:5616
    ds_read_b128 v[132:135], v196 offset:5728
    ds_read_b128 v[136:139], v196 offset:5744
    ds_read_b128 v[140:143], v196 offset:4928
    ds_read_b128 v[144:147], v196 offset:4944
    ds_read_b128 v[148:151], v196 offset:4128
    ds_read_b128 v[152:155], v196 offset:4144
    ds_read_b128 v[156:159], v196 offset:3328
    ds_read_b128 v[160:163], v196 offset:3344
    ds_read_b128 v[164:167], v196 offset:2528
    ds_read_b128 v[168:171], v196 offset:2544
    ds_read_b128 v[172:175], v196 offset:1728
    ds_read_b128 v[176:179], v196 offset:1744
    ds_read_b128 v[180:183], v196 offset:928
    ds_read_b128 v[184:187], v196 offset:944
    ds_read_b128 v[188:191], v196 offset:128
    ds_read_b128 v[192:195], v196 offset:144
    v_add_u32 v206, s33, v197
    v_cmp_le_u32 s[50:51], 2, v206
    v_cmp_le_u32 s[52:53], 4, v206
    v_cmp_le_u32 s[54:55], 6, v206
    v_cmp_le_u32 s[64:65], 8, v206
    v_cmp_le_u32 s[66:67], 10, v206
    v_cmp_le_u32 s[68:69], 12, v206
    v_cmp_le_u32 s[70:71], 14, v206
    s_waitcnt lgkmcnt(0)
    ds_read_b128 v[40:43], v196 offset:5856
    ds_read_b128 v[44:47], v196 offset:5872
    ds_read_b128 v[48:51], v196 offset:5056
    ds_read_b128 v[52:55], v196 offset:5072
    ds_read_b128 v[56:59], v196 offset:4256
    ds_read_b128 v[60:63], v196 offset:4272
    ds_read_b128 v[64:67], v196 offset:3456
    ds_read_b128 v[68:71], v196 offset:3472
    ds_read_b128 v[72:75], v196 offset:2656
    ds_read_b128 v[76:79], v196 offset:2672
    ds_read_b128 v[80:83], v196 offset:1856
    ds_read_b128 v[84:87], v196 offset:1872
    ds_read_b128 v[88:91], v196 offset:1056
    ds_read_b128 v[92:95], v196 offset:1072
    ds_read_b128 v[96:99], v196 offset:256
    ds_read_b128 v[100:103], v196 offset:272
    v_dot2_f32_bf16 v198, v124, v132, 0
    v_dot2_f32_bf16 v199, v124, v140, 0
    v_dot2_f32_bf16 v200, v124, v148, 0
    v_dot2_f32_bf16 v201, v124, v156, 0
    v_dot2_f32_bf16 v202, v124, v164, 0
    v_dot2_f32_bf16 v203, v124, v172, 0
    v_dot2_f32_bf16 v204, v124, v180, 0
    v_dot2_f32_bf16 v205, v124, v188, 0
    v_dot2_f32_bf16 v198, v125, v133, v198
    v_dot2_f32_bf16 v199, v125, v141, v199
    v_dot2_f32_bf16 v200, v125, v149, v200
    v_dot2_f32_bf16 v201, v125, v157, v201
    v_dot2_f32_bf16 v202, v125, v165, v202
    v_dot2_f32_bf16 v203, v125, v173, v203
    v_dot2_f32_bf16 v204, v125, v181, v204
    v_dot2_f32_bf16 v205, v125, v189, v205
    v_dot2_f32_bf16 v198, v126, v134, v198
    v_dot2_f32_bf16 v199, v126, v142, v199
    v_dot2_f32_bf16 v200, v126, v150, v200
    v_dot2_f32_bf16 v201, v126, v158, v201
    v_dot2_f32_bf16 v202, v126, v166, v202
    v_dot2_f32_bf16 v203, v126, v174, v203
    v_dot2_f32_bf16 v204, v126, v182, v204
    v_dot2_f32_bf16 v205, v126, v190, v205
    v_dot2_f32_bf16 v198, v127, v135, v198
    v_dot2_f32_bf16 v199, v127, v143, v199
    v_dot2_f32_bf16 v200, v127, v151, v200
    v_dot2_f32_bf16 v201, v127, v159, v201
    v_dot2_f32_bf16 v202, v127, v167, v202
    v_dot2_f32_bf16 v203, v127, v175, v203
    v_dot2_f32_bf16 v204, v127, v183, v204
    v_dot2_f32_bf16 v205, v127, v191, v205
    v_dot2_f32_bf16 v198, v128, v136, v198
    v_dot2_f32_bf16 v199, v128, v144, v199
    v_dot2_f32_bf16 v200, v128, v152, v200
    v_dot2_f32_bf16 v201, v128, v160, v201
    v_dot2_f32_bf16 v202, v128, v168, v202
    v_dot2_f32_bf16 v203, v128, v176, v203
    v_dot2_f32_bf16 v204, v128, v184, v204
    v_dot2_f32_bf16 v205, v128, v192, v205
    v_dot2_f32_bf16 v198, v129, v137, v198
    v_dot2_f32_bf16 v199, v129, v145, v199
    v_dot2_f32_bf16 v200, v129, v153, v200
    v_dot2_f32_bf16 v201, v129, v161, v201
    v_dot2_f32_bf16 v202, v129, v169, v202
    v_dot2_f32_bf16 v203, v129, v177, v203
    v_dot2_f32_bf16 v204, v129, v185, v204
    v_dot2_f32_bf16 v205, v129, v193, v205
    v_dot2_f32_bf16 v198, v130, v138, v198
    v_dot2_f32_bf16 v199, v130, v146, v199
    v_dot2_f32_bf16 v200, v130, v154, v200
    v_dot2_f32_bf16 v201, v130, v162, v201
    v_dot2_f32_bf16 v202, v130, v170, v202
    v_dot2_f32_bf16 v203, v130, v178, v203
    v_dot2_f32_bf16 v204, v130, v186, v204
    v_dot2_f32_bf16 v205, v130, v194, v205
    v_dot2_f32_bf16 v198, v131, v139, v198
    v_dot2_f32_bf16 v199, v131, v147, v199
    v_dot2_f32_bf16 v200, v131, v155, v200
    v_dot2_f32_bf16 v201, v131, v163, v201
    v_dot2_f32_bf16 v202, v131, v171, v202
    v_dot2_f32_bf16 v203, v131, v179, v203
    v_dot2_f32_bf16 v204, v131, v187, v204
    v_dot2_f32_bf16 v205, v131, v195, v205
    s_cmp_eq_u32 s85, 0
    s_cbranch_scc1 C_SUa_S
C_SUa_R:
    s_getreg_b32 s31, hwreg(HW_REG_IB_STS)
    s_lshr_b32 s32, s31, 18
    s_and_b32 s32, s32, 0x30
    s_and_b32 s31, s31, 15
    s_or_b32 s31, s31, s32
    s_cmp_gt_u32 s31, s76
    s_cbranch_scc1 C_SUa_S
    v_mov_b32 v2, s85
    v_mov_b32 v3, 1
    s_mov_b32 s85, 0
    s_mov_b64 exec, 1
    ds_add_rtn_u32 v3, v2, v3
    s_waitcnt lgkmcnt(0)
    v_readfirstlane_b32 s31, v3
    s_cmp_lg_u32 s31, 3
    s_cbranch_scc1 C_SUa_N
    s_mov_b32 exec_lo, s87
    v_mov_b32 v3, s40
    buffer_store_dword v3, v28, s[44:47], s86 offen sc1
C_SUa_N:
    s_mov_b64 exec, -1
C_SUa_S:
    v_cvt_pk_bf16_f32 v207, v198, v199
    v_cvt_pk_bf16_f32 v208, v200, v201
    v_cvt_pk_bf16_f32 v209, v202, v203
    v_cvt_pk_bf16_f32 v210, v204, v205
    v_lshlrev_b32 v198, 16, v207
    v_and_b32 v199, 0xffff0000, v207
    v_lshlrev_b32 v200, 16, v208
    v_and_b32 v201, 0xffff0000, v208
    v_lshlrev_b32 v202, 16, v209
    v_and_b32 v203, 0xffff0000, v209
    v_lshlrev_b32 v204, 16, v210
    v_and_b32 v205, 0xffff0000, v210
    v_mov_b32 v2, 0xf149f2ca
    v_cndmask_b32 v199, v2, v199, s[50:51]
    v_cndmask_b32 v200, v2, v200, s[52:53]
    v_cndmask_b32 v201, v2, v201, s[54:55]
    v_cndmask_b32 v202, v2, v202, s[64:65]
    v_cndmask_b32 v203, v2, v203, s[66:67]
    v_cndmask_b32 v204, v2, v204, s[68:69]
    v_cndmask_b32 v205, v2, v205, s[70:71]
    s_cmp_eq_u32 s85, 0
    s_cbranch_scc1 C_SU0_S
C_SU0_R:
    s_getreg_b32 s31, hwreg(HW_REG_IB_STS)
    s_lshr_b32 s32, s31, 18
    s_and_b32 s32, s32, 0x30
    s_and_b32 s31, s31, 15
    s_or_b32 s31, s31, s32
    s_cmp_gt_u32 s31, s76
    s_cbranch_scc1 C_SU0_S
    v_mov_b32 v2, s85
    v_mov_b32 v3, 1
    s_mov_b32 s85, 0
    s_mov_b64 exec, 1
    ds_add_rtn_u32 v3, v2, v3
    s_waitcnt lgkmcnt(0)
    v_readfirstlane_b32 s31, v3
    s_cmp_lg_u32 s31, 3
    s_cbranch_scc1 C_SU0_N
    s_mov_b32 exec_lo, s87
    v_mov_b32 v3, s40
    buffer_store_dword v3, v28, s[44:47], s86 offen sc1
C_SU0_N:
    s_mov_b64 exec, -1
C_SU0_S:
    v_max3_f32 v211, v198, v199, v200
    v_max3_f32 v211, v211, v201, v202
    v_max3_f32 v211, v211, v203, v204
    v_max_f32 v211, v211, v205
    v_sub_f32 v198, v198, v211
    v_sub_f32 v199, v199, v211
    v_sub_f32 v200, v200, v211
    v_sub_f32 v201, v201, v211
    v_sub_f32 v202, v202, v211
    v_sub_f32 v203, v203, v211
    v_sub_f32 v204, v204, v211
    v_sub_f32 v205, v205, v211
    v_mul_f32 v198, 0x3eb8aa3b, v198
    v_mul_f32 v199, 0x3eb8aa3b, v199
    v_mul_f32 v200, 0x3eb8aa3b, v200
    v_mul_f32 v201, 0x3eb8aa3b, v201
    v_mul_f32 v202, 0x3eb8aa3b, v202
    v_mul_f32 v203, 0x3eb8aa3b, v203
    v_mul_f32 v204, 0x3eb8aa3b, v204
    v_mul_f32 v205, 0x3eb8aa3b, v205
    v_exp_f32 v198, v198
    v_exp_f32 v199, v199
    v_exp_f32 v200, v200
    v_exp_f32 v201, v201
    v_exp_f32 v202, v202
    v_exp_f32 v203, v203
    v_exp_f32 v204, v204
    v_exp_f32 v205, v205
    s_nop 0
    v_add_f32 v211, v198, v199
    v_add_f32 v211, v211, v200
    v_add_f32 v211, v211, v201
    v_add_f32 v211, v211, v202
    v_add_f32 v211, v211, v203
    v_add_f32 v211, v211, v204
    v_add_f32 v211, v211, v205
    v_rcp_f32 v211, v211
    s_nop 0
    v_mul_f32 v198, v198, v211
    v_mul_f32 v199, v199, v211
    v_mul_f32 v200, v200, v211
    v_mul_f32 v201, v201, v211
    v_mul_f32 v202, v202, v211
    v_mul_f32 v203, v203, v211
    v_mul_f32 v204, v204, v211
    v_mul_f32 v205, v205, v211
    v_cvt_pk_bf16_f32 v207, v198, v199
    v_cvt_pk_bf16_f32 v208, v200, v201
    v_cvt_pk_bf16_f32 v209, v202, v203
    v_cvt_pk_bf16_f32 v210, v204, v205
    s_cmp_eq_u32 s85, 0
    s_cbranch_scc1 C_SUb_S
C_SUb_R:
    s_getreg_b32 s31, hwreg(HW_REG_IB_STS)
    s_lshr_b32 s32, s31, 18
    s_and_b32 s32, s32, 0x30
    s_and_b32 s31, s31, 15
    s_or_b32 s31, s31, s32
    s_cmp_gt_u32 s31, s76
    s_cbranch_scc1 C_SUb_S
    v_mov_b32 v2, s85
    v_mov_b32 v3, 1
    s_mov_b32 s85, 0
    s_mov_b64 exec, 1
    ds_add_rtn_u32 v3, v2, v3
    s_waitcnt lgkmcnt(0)
    v_readfirstlane_b32 s31, v3
    s_cmp_lg_u32 s31, 3
    s_cbranch_scc1 C_SUb_N
    s_mov_b32 exec_lo, s87
    v_mov_b32 v3, s40
    buffer_store_dword v3, v28, s[44:47], s86 offen sc1
C_SUb_N:
    s_mov_b64 exec, -1
C_SUb_S:
    s_mov_b32 s10, 0x05040100
    s_mov_b32 s11, 0x07060302
    s_waitcnt lgkmcnt(0)
    v_perm_b32 v228, v48, v40, s10
    v_perm_b32 v229, v48, v40, s11
    v_perm_b32 v230, v49, v41, s10
    v_perm_b32 v231, v49, v41, s11
    v_perm_b32 v232, v50, v42, s10
    v_perm_b32 v233, v50, v42, s11
    v_perm_b32 v234, v51, v43, s10
    v_perm_b32 v235, v51, v43, s11
    v_perm_b32 v236, v52, v44, s10
    v_perm_b32 v237, v52, v44, s11
    v_perm_b32 v238, v53, v45, s10
    v_perm_b32 v239, v53, v45, s11
    v_perm_b32 v240, v54, v46, s10
    v_perm_b32 v241, v54, v46, s11
    v_perm_b32 v242, v55, v47, s10
    v_perm_b32 v243, v55, v47, s11
    v_dot2_f32_bf16 v212, v228, v207, 0
    v_dot2_f32_bf16 v213, v229, v207, 0
    v_dot2_f32_bf16 v214, v230, v207, 0
    v_dot2_f32_bf16 v215, v231, v207, 0
    v_dot2_f32_bf16 v216, v232, v207, 0
    v_dot2_f32_bf16 v217, v233, v207, 0
    v_dot2_f32_bf16 v218, v234, v207, 0
    v_dot2_f32_bf16 v219, v235, v207, 0
    v_dot2_f32_bf16 v220, v236, v207, 0
    v_dot2_f32_bf16 v221, v237, v207, 0
    v_dot2_f32_bf16 v222, v238, v207, 0
    v_dot2_f32_bf16 v223, v239, v207, 0
    v_dot2_f32_bf16 v224, v240, v207, 0
    v_dot2_f32_bf16 v225, v241, v207, 0
    v_dot2_f32_bf16 v226, v242, v207, 0
    v_dot2_f32_bf16 v227, v243, v207, 0
    v_perm_b32 v228, v64, v56, s10
    v_perm_b32 v229, v64, v56, s11
    v_perm_b32 v230, v65, v57, s10
    v_perm_b32 v231, v65, v57, s11
    v_perm_b32 v232, v66, v58, s10
    v_perm_b32 v233, v66, v58, s11
    v_perm_b32 v234, v67, v59, s10
    v_perm_b32 v235, v67, v59, s11
    v_perm_b32 v236, v68, v60, s10
    v_perm_b32 v237, v68, v60, s11
    v_perm_b32 v238, v69, v61, s10
    v_perm_b32 v239, v69, v61, s11
    v_perm_b32 v240, v70, v62, s10
    v_perm_b32 v241, v70, v62, s11
    v_perm_b32 v242, v71, v63, s10
    v_perm_b32 v243, v71, v63, s11
    v_dot2_f32_bf16 v212, v228, v208, v212
    v_dot2_f32_bf16 v213, v229, v208, v213
    v_dot2_f32_bf16 v214, v230, v208, v214
    v_dot2_f32_bf16 v215, v231, v208, v215
    v_dot2_f32_bf16 v216, v232, v208, v216
    v_dot2_f32_bf16 v217, v233, v208, v217
    v_dot2_f32_bf16 v218, v234, v208, v218
    v_dot2_f32_bf16 v219, v235, v208, v219
    v_dot2_f32_bf16 v220, v236, v208, v220
    v_dot2_f32_bf16 v221, v237, v208, v221
    v_dot2_f32_bf16 v222, v238, v208, v222
    v_dot2_f32_bf16 v223, v239, v208, v223
    v_dot2_f32_bf16 v224, v240, v208, v224
    v_dot2_f32_bf16 v225, v241, v208, v225
    v_dot2_f32_bf16 v226, v242, v208, v226
    v_dot2_f32_bf16 v227, v243, v208, v227
    v_perm_b32 v228, v80, v72, s10
    v_perm_b32 v229, v80, v72, s11
    v_perm_b32 v230, v81, v73, s10
    v_perm_b32 v231, v81, v73, s11
    v_perm_b32 v232, v82, v74, s10
    v_perm_b32 v233, v82, v74, s11
    v_perm_b32 v234, v83, v75, s10
    v_perm_b32 v235, v83, v75, s11
    v_perm_b32 v236, v84, v76, s10
    v_perm_b32 v237, v84, v76, s11
    v_perm_b32 v238, v85, v77, s10
    v_perm_b32 v239, v85, v77, s11
    v_perm_b32 v240, v86, v78, s10
    v_perm_b32 v241, v86, v78, s11
    v_perm_b32 v242, v87, v79, s10
    v_perm_b32 v243, v87, v79, s11
    v_dot2_f32_bf16 v212, v228, v209, v212
    v_dot2_f32_bf16 v213, v229, v209, v213
    v_dot2_f32_bf16 v214, v230, v209, v214
    v_dot2_f32_bf16 v215, v231, v209, v215
    v_dot2_f32_bf16 v216, v232, v209, v216
    v_dot2_f32_bf16 v217, v233, v209, v217
    v_dot2_f32_bf16 v218, v234, v209, v218
    v_dot2_f32_bf16 v219, v235, v209, v219
    v_dot2_f32_bf16 v220, v236, v209, v220
    v_dot2_f32_bf16 v221, v237, v209, v221
    v_dot2_f32_bf16 v222, v238, v209, v222
    v_dot2_f32_bf16 v223, v239, v209, v223
    v_dot2_f32_bf16 v224, v240, v209, v224
    v_dot2_f32_bf16 v225, v241, v209, v225
    v_dot2_f32_bf16 v226, v242, v209, v226
    v_dot2_f32_bf16 v227, v243, v209, v227
    v_perm_b32 v228, v96, v88, s10
    v_perm_b32 v229, v96, v88, s11
    v_perm_b32 v230, v97, v89, s10
    v_perm_b32 v231, v97, v89, s11
    v_perm_b32 v232, v98, v90, s10
    v_perm_b32 v233, v98, v90, s11
    v_perm_b32 v234, v99, v91, s10
    v_perm_b32 v235, v99, v91, s11
    v_perm_b32 v236, v100, v92, s10
    v_perm_b32 v237, v100, v92, s11
    v_perm_b32 v238, v101, v93, s10
    v_perm_b32 v239, v101, v93, s11
    v_perm_b32 v240, v102, v94, s10
    v_perm_b32 v241, v102, v94, s11
    v_perm_b32 v242, v103, v95, s10
    v_perm_b32 v243, v103, v95, s11
    v_dot2_f32_bf16 v212, v228, v210, v212
    v_dot2_f32_bf16 v213, v229, v210, v213
    v_dot2_f32_bf16 v214, v230, v210, v214
    v_dot2_f32_bf16 v215, v231, v210, v215
    v_dot2_f32_bf16 v216, v232, v210, v216
    v_dot2_f32_bf16 v217, v233, v210, v217
    v_dot2_f32_bf16 v218, v234, v210, v218
    v_dot2_f32_bf16 v219, v235, v210, v219
    v_dot2_f32_bf16 v220, v236, v210, v220
    v_dot2_f32_bf16 v221, v237, v210, v221
    v_dot2_f32_bf16 v222, v238, v210, v222
    v_dot2_f32_bf16 v223, v239, v210, v223
    v_dot2_f32_bf16 v224, v240, v210, v224
    v_dot2_f32_bf16 v225, v241, v210, v225
    v_dot2_f32_bf16 v226, v242, v210, v226
    v_dot2_f32_bf16 v227, v243, v210, v227
    s_nop 2
    v_cvt_pk_bf16_f32 v124, v212, v213
    v_cvt_pk_bf16_f32 v125, v214, v215
    v_cvt_pk_bf16_f32 v126, v216, v217
    v_cvt_pk_bf16_f32 v127, v218, v219
    v_cvt_pk_bf16_f32 v128, v220, v221
    v_cvt_pk_bf16_f32 v129, v222, v223
    v_cvt_pk_bf16_f32 v130, v224, v225
    v_cvt_pk_bf16_f32 v131, v226, v227
    s_cmp_eq_u32 s85, 0
    s_cbranch_scc1 C_SU1_S
C_SU1_R:
    s_getreg_b32 s31, hwreg(HW_REG_IB_STS)
    s_lshr_b32 s32, s31, 18
    s_and_b32 s32, s32, 0x30
    s_and_b32 s31, s31, 15
    s_or_b32 s31, s31, s32
    s_cmp_gt_u32 s31, s76
    s_cbranch_scc1 C_SU1_R
    v_mov_b32 v2, s85
    v_mov_b32 v3, 1
    s_mov_b32 s85, 0
    s_mov_b64 exec, 1
    ds_add_rtn_u32 v3, v2, v3
    s_waitcnt lgkmcnt(0)
    v_readfirstlane_b32 s31, v3
    s_cmp_lg_u32 s31, 3
    s_cbranch_scc1 C_SU1_N
    s_mov_b32 exec_lo, s87
    v_mov_b32 v3, s40
    buffer_store_dword v3, v28, s[44:47], s86 offen sc1
C_SU1_N:
    s_mov_b64 exec, -1
C_SU1_S:
    v_lshlrev_b32 v196, 7, v197
    v_and_b32 v2, 3, v1
    v_lshl_add_u32 v196, v2, 5, v196
    v_add_u32 v196, 0x24040, v196
    ds_write_b128 v196, v[124:127]
    ds_write_b128 v196, v[128:131] offset:16
    s_lshl_b32 s31, s29, 11
    s_add_u32 s31, s31, 0x24040
    v_add_u32 v196, s31, v4
    v_lshrrev_b32 v206, 3, v1
    v_lshlrev_b32 v206, 10, v206
    v_and_b32 v2, 7, v1
    v_lshl_add_u32 v206, v2, 4, v206
    s_lshl_b32 s31, s29, 4
    s_add_u32 s31, s31, s33
    s_lshl_b32 s31, s31, 10
    s_lshl_b32 s32, s34, 7
    s_add_u32 s31, s31, s32
    s_add_u32 s32, s31, 8192
    s_waitcnt lgkmcnt(0)
    ds_read_b128 v[124:127], v196
    ds_read_b128 v[128:131], v196 offset:1024
    s_waitcnt lgkmcnt(1)
    buffer_store_dwordx4 v[124:127], v206, s[56:59], s31 offen sc1
    s_waitcnt lgkmcnt(0)
    buffer_store_dwordx4 v[128:131], v206, s[56:59], s32 offen sc1
    v_and_b32 v28, 3, v1
    v_lshlrev_b32 v28, 3, v28
    v_lshrrev_b32 v2, 2, v1
    v_add_u32 v28, v2, v28
    s_bfe_u32 s31, s33, 0x30006
    s_lshl_b32 s31, s31, 5
    s_lshr_b32 s32, s33, 9
    s_lshl_b32 s32, s32, 1
    s_add_u32 s31, s31, s32
    v_add_u32 v28, s31, v28
    v_lshlrev_b32 v28, 7, v28
    s_mov_b32 s87, 0xff
    s_lshl_b32 s31, s34, 2
    s_add_u32 s31, s31, 40960
    s_mov_b32 s86, s31
    s_mov_b32 s85, 147464
    s_mov_b32 s76, 0
    s_mov_b32 s64, s18
    s_and_b32 s65, s19, 0xffff
    s_mov_b32 s66, 0x1000
    s_mov_b32 s67, 0x20000
    s_mov_b32 s68, s22
    s_and_b32 s69, s23, 0xffff
    s_mov_b32 s70, 0x200000
    s_mov_b32 s71, 0x20000
    v_mov_b32 v132, 0
    v_mov_b32 v148, 0
    v_mov_b32 v133, 0
    v_mov_b32 v149, 0
    v_mov_b32 v134, 0
    v_mov_b32 v150, 0
    v_mov_b32 v135, 0
    v_mov_b32 v151, 0
    v_mov_b32 v136, 0
    v_mov_b32 v152, 0
    v_mov_b32 v137, 0
    v_mov_b32 v153, 0
    v_mov_b32 v138, 0
    v_mov_b32 v154, 0
    v_mov_b32 v139, 0
    v_mov_b32 v155, 0
    v_mov_b32 v140, 0
    v_mov_b32 v156, 0
    v_mov_b32 v141, 0
    v_mov_b32 v157, 0
    v_mov_b32 v142, 0
    v_mov_b32 v158, 0
    v_mov_b32 v143, 0
    v_mov_b32 v159, 0
    v_mov_b32 v144, 0
    v_mov_b32 v160, 0
    v_mov_b32 v145, 0
    v_mov_b32 v161, 0
    v_mov_b32 v146, 0
    v_mov_b32 v162, 0
    v_mov_b32 v147, 0
    v_mov_b32 v163, 0
    v_bfe_u32 v2, v1, 1, 3
    v_lshrrev_b32 v3, 5, v1
    v_xor_b32 v2, v2, v3
    v_and_b32 v3, 31, v1
    v_lshlrev_b32 v3, 7, v3
    v_xor_b32 v31, 0, v2
    v_lshl_add_u32 v31, v31, 4, v3
    v_xor_b32 v32, 2, v2
    v_lshl_add_u32 v32, v32, 4, v3
    v_xor_b32 v33, 4, v2
    v_lshl_add_u32 v33, v33, 4, v3
    v_xor_b32 v34, 6, v2
    v_lshl_add_u32 v34, v34, 4, v3
    s_lshl_b32 s31, s90, 12
    s_lshl_b32 s32, s91, 12
    s_add_u32 s32, s32, 8192
    v_add_u32 v35, s32, v31
    v_add_u32 v31, s31, v31
    v_add_u32 v36, s32, v32
    v_add_u32 v32, s31, v32
    v_add_u32 v37, s32, v33
    v_add_u32 v33, s31, v33
    v_add_u32 v38, s32, v34
    v_add_u32 v34, s31, v34
    v_lshrrev_b32 v30, 5, v1
    v_lshlrev_b32 v30, 3, v30
    v_bfe_u32 v2, v1, 2, 2
    v_add_u32 v30, v30, v2
    v_lshlrev_b32 v30, 7, v30
    v_bfe_u32 v2, v1, 3, 1
    v_xor_b32 v2, s91, v2
    v_lshl_add_u32 v30, v2, 6, v30
    v_bfe_u32 v2, v1, 4, 1
    v_lshl_add_u32 v30, v2, 5, v30
    v_bfe_u32 v2, v1, 1, 1
    v_lshl_add_u32 v30, v2, 4, v30
    v_and_b32 v2, 1, v1
    v_lshl_add_u32 v30, v2, 3, v30
    v_add_u32 v30, 0x2000, v30
    v_lshrrev_b32 v29, 5, v1
    v_lshlrev_b32 v29, 3, v29
    v_bfe_u32 v2, v1, 2, 2
    v_add_u32 v29, v29, v2
    v_lshlrev_b32 v29, 7, v29
    v_bfe_u32 v2, v1, 3, 1
    v_xor_b32 v2, s90, v2
    v_lshl_add_u32 v29, v2, 6, v29
    v_bfe_u32 v2, v1, 4, 1
    v_lshl_add_u32 v29, v2, 5, v29
    v_bfe_u32 v2, v1, 1, 1
    v_lshl_add_u32 v29, v2, 4, v29
    v_and_b32 v2, 1, v1
    v_lshl_add_u32 v29, v2, 3, v29
    v_mov_b32 v228, v31
    v_mov_b32 v229, v32
    v_mov_b32 v230, v33
    v_mov_b32 v231, v34
    v_mov_b32 v232, v35
    v_mov_b32 v233, v36
    v_mov_b32 v234, v37
    v_mov_b32 v235, v38
    v_mov_b32 v236, v30
    v_mov_b32 v237, v29
    v_and_b32 v105, 31, v1
    s_lshl_b32 s31, s37, 6
    s_lshl_b32 s32, s91, 5
    s_add_u32 s31, s31, s32
    v_add_u32 v105, s31, v105
    v_lshlrev_b32 v3, 1, v105
    buffer_load_ushort v107, v3, s[64:67], 0 offen
    s_add_u32 s76, s76, 1
    s_cmp_eq_u32 s29, 0
    s_cselect_b32 s92, 0, 2
    s_cmp_lt_u32 s38, 28
    s_cbranch_scc1 C_NPF
    s_cmp_eq_u32 s85, 0
    s_cbranch_scc1 C_SO0_S
C_SO0_R:
    s_getreg_b32 s31, hwreg(HW_REG_IB_STS)
    s_lshr_b32 s32, s31, 18
    s_and_b32 s32, s32, 0x30
    s_and_b32 s31, s31, 15
    s_or_b32 s31, s31, s32
    s_cmp_gt_u32 s31, s76
    s_cbranch_scc1 C_SO0_R
    v_mov_b32 v2, s85
    v_mov_b32 v3, 1
    s_mov_b32 s85, 0
    s_mov_b64 exec, 1
    ds_add_rtn_u32 v3, v2, v3
    s_waitcnt lgkmcnt(0)
    v_readfirstlane_b32 s31, v3
    s_cmp_lg_u32 s31, 3
    s_cbranch_scc1 C_SO0_N
    s_mov_b32 exec_lo, s87
    v_mov_b32 v3, s40
    buffer_store_dword v3, v28, s[44:47], s86 offen sc1
C_SO0_N:
    s_mov_b64 exec, -1
C_SO0_S:
    s_mov_b32 s80, s16
    s_and_b32 s81, s17, 0xffff
    s_mov_b32 s82, 0x700000
    s_mov_b32 s83, 0x20000
    v_lshrrev_b32 v21, 3, v1
    v_lshlrev_b32 v21, 12, v21
    v_and_b32 v2, 7, v1
    v_lshl_add_u32 v21, v2, 7, v21
    s_sub_u32 s31, s84, 112
    s_lshl_b32 s31, s31, 15
    s_bfe_u32 s32, s2, 0x20001
    s_lshl_b32 s32, s32, 10
    s_add_u32 s31, s31, s32
    s_mov_b32 s39, 0
C_PFW2:
    buffer_load_dword v20, v21, s[80:83], s31 offen
    s_add_u32 s31, s31, 524288
    v_mov_b32 v2, 147480
    ds_read_b32 v2, v2
    s_waitcnt vmcnt(2) lgkmcnt(0)
    v_readfirstlane_b32 s32, v2
    s_cmp_eq_u32 s32, s40
    s_cbranch_scc1 C_NPF
    s_add_u32 s39, s39, 1
    s_cmp_lt_u32 s39, 8
    s_cbranch_scc1 C_PFW2
C_NPF:
    s_lshl_b32 s93, s2, 7
    s_add_u32 s93, s93, 40960
    v_and_b32 v121, 7, v1
    v_lshlrev_b32 v121, 2, v121
    s_mov_b32 s88, 0
    s_barrier
    ds_read_b128 v[164:167], v31
    ds_read_b64_tr_b16 v[168:169], v30 offset:0
    ds_read_b64_tr_b16 v[170:171], v30 offset:512
    ds_read_b128 v[172:175], v32
    ds_read_b64_tr_b16 v[176:177], v30 offset:2048
    ds_read_b64_tr_b16 v[178:179], v30 offset:2560
    ds_read_b128 v[180:183], v33
    ds_read_b64_tr_b16 v[184:185], v30 offset:4096
    ds_read_b64_tr_b16 v[186:187], v30 offset:4608
    ds_read_b128 v[188:191], v34
    ds_read_b64_tr_b16 v[192:193], v30 offset:6144
    ds_read_b64_tr_b16 v[194:195], v30 offset:6656
    v_lshlrev_b32 v2, 2, v105
    buffer_load_dword v106, v2, s[60:63], 0 offen
    s_add_u32 s76, s76, 1
    s_mov_b32 s39, 0
C_PB:
    s_barrier
    s_add_u32 s88, s88, 16384
    s_cmp_eq_u32 s88, 147456
    s_cselect_b32 s89, 0xfffe0000, s75
    s_cselect_b32 s88, 0, s88
    v_add_u32 v31, s89, v31
    v_add_u32 v32, s89, v32
    v_add_u32 v33, s89, v33
    v_add_u32 v34, s89, v34
    v_add_u32 v30, s89, v30
    s_waitcnt lgkmcnt(9)
    v_mfma_f32_32x32x16_bf16 v[148:163], v[164:167], v[168:171], v[148:163]
    ds_read_b128 v[196:199], v31
    ds_read_b64_tr_b16 v[200:201], v30 offset:0
    ds_read_b64_tr_b16 v[202:203], v30 offset:512
    s_waitcnt lgkmcnt(9)
    v_mfma_f32_32x32x16_bf16 v[148:163], v[172:175], v[176:179], v[148:163]
    ds_read_b128 v[204:207], v32
    ds_read_b64_tr_b16 v[208:209], v30 offset:2048
    ds_read_b64_tr_b16 v[210:211], v30 offset:2560
    s_waitcnt lgkmcnt(9)
    v_mfma_f32_32x32x16_bf16 v[148:163], v[180:183], v[184:187], v[148:163]
    ds_read_b128 v[212:215], v33
    ds_read_b64_tr_b16 v[216:217], v30 offset:4096
    ds_read_b64_tr_b16 v[218:219], v30 offset:4608
    s_waitcnt lgkmcnt(9)
    v_mfma_f32_32x32x16_bf16 v[148:163], v[188:191], v[192:195], v[148:163]
    ds_read_b128 v[220:223], v34
    ds_read_b64_tr_b16 v[224:225], v30 offset:6144
    ds_read_b64_tr_b16 v[226:227], v30 offset:6656
    s_cmp_eq_u32 s85, 0
    s_cbranch_scc1 C_SO2_S
C_SO2_R:
    s_getreg_b32 s31, hwreg(HW_REG_IB_STS)
    s_lshr_b32 s32, s31, 18
    s_and_b32 s32, s32, 0x30
    s_and_b32 s31, s31, 15
    s_or_b32 s31, s31, s32
    s_cmp_gt_u32 s31, s76
    s_cbranch_scc1 C_SO2_S
    v_mov_b32 v2, s85
    v_mov_b32 v3, 1
    s_mov_b32 s85, 0
    s_mov_b64 exec, 1
    ds_add_rtn_u32 v3, v2, v3
    s_waitcnt lgkmcnt(0)
    v_readfirstlane_b32 s31, v3
    s_cmp_lg_u32 s31, 3
    s_cbranch_scc1 C_SO2_N
    s_mov_b32 exec_lo, s87
    v_mov_b32 v3, s40
    buffer_store_dword v3, v28, s[44:47], s86 offen sc1
C_SO2_N:
    s_mov_b64 exec, -1
C_SO2_S:
    s_cmp_lt_u32 s39, 10
    s_cbranch_scc1 C_PO_X
    s_cmp_eq_u32 s92, 2
    s_cbranch_scc1 C_PO_X
    s_cmp_eq_u32 s92, 1
    s_cbranch_scc1 C_PO_E
    buffer_load_dword v120, v121, s[44:47], s93 offen sc1
    s_mov_b32 s92, 1
    s_add_u32 s76, s76, 1
    s_branch C_PO_X
C_PO_E:
    s_getreg_b32 s31, hwreg(HW_REG_IB_STS)
    s_and_b32 s31, s31, 0xc0000f
    s_cbranch_scc1 C_PO_X
    s_mov_b32 s92, 0
    v_cmp_ne_u32 vcc, s40, v120
    s_cmp_lg_u64 vcc, 0
    s_cbranch_scc1 C_PO_X
    v_mov_b32 v2, 147476
    v_mov_b32 v3, s40
    ds_write_b32 v2, v3
    s_mov_b32 s92, 2
C_PO_X:
    s_barrier
    s_add_u32 s88, s88, 16384
    s_cmp_eq_u32 s88, 147456
    s_cselect_b32 s89, 0xfffe0000, s75
    s_cselect_b32 s88, 0, s88
    v_add_u32 v31, s89, v31
    v_add_u32 v32, s89, v32
    v_add_u32 v33, s89, v33
    v_add_u32 v34, s89, v34
    v_add_u32 v30, s89, v30
    s_waitcnt lgkmcnt(9)
    v_mfma_f32_32x32x16_bf16 v[148:163], v[196:199], v[200:203], v[148:163]
    ds_read_b128 v[164:167], v31
    ds_read_b64_tr_b16 v[168:169], v30 offset:0
    ds_read_b64_tr_b16 v[170:171], v30 offset:512
    s_waitcnt lgkmcnt(9)
    v_mfma_f32_32x32x16_bf16 v[148:163], v[204:207], v[208:211], v[148:163]
    ds_read_b128 v[172:175], v32
    ds_read_b64_tr_b16 v[176:177], v30 offset:2048
    ds_read_b64_tr_b16 v[178:179], v30 offset:2560
    s_waitcnt lgkmcnt(9)
    v_mfma_f32_32x32x16_bf16 v[148:163], v[212:215], v[216:219], v[148:163]
    ds_read_b128 v[180:183], v33
    ds_read_b64_tr_b16 v[184:185], v30 offset:4096
    ds_read_b64_tr_b16 v[186:187], v30 offset:4608
    s_waitcnt lgkmcnt(9)
    v_mfma_f32_32x32x16_bf16 v[148:163], v[220:223], v[224:227], v[148:163]
    ds_read_b128 v[188:191], v34
    ds_read_b64_tr_b16 v[192:193], v30 offset:6144
    ds_read_b64_tr_b16 v[194:195], v30 offset:6656
    s_add_u32 s39, s39, 2
    s_cmp_lt_u32 s39, 18
    s_cbranch_scc1 C_PB
    s_cmp_eq_u32 s85, 0
    s_cbranch_scc1 C_SO3_S
C_SO3_R:
    s_getreg_b32 s31, hwreg(HW_REG_IB_STS)
    s_lshr_b32 s32, s31, 18
    s_and_b32 s32, s32, 0x30
    s_and_b32 s31, s31, 15
    s_or_b32 s31, s31, s32
    s_cmp_gt_u32 s31, s76
    s_cbranch_scc1 C_SO3_R
    v_mov_b32 v2, s85
    v_mov_b32 v3, 1
    s_mov_b32 s85, 0
    s_mov_b64 exec, 1
    ds_add_rtn_u32 v3, v2, v3
    s_waitcnt lgkmcnt(0)
    v_readfirstlane_b32 s31, v3
    s_cmp_lg_u32 s31, 3
    s_cbranch_scc1 C_SO3_N
    s_mov_b32 exec_lo, s87
    v_mov_b32 v3, s40
    buffer_store_dword v3, v28, s[44:47], s86 offen sc1
C_SO3_N:
    s_mov_b64 exec, -1
C_SO3_S:
    s_mov_b32 s32, 0
C_POB:
    s_cmp_eq_u32 s92, 2
    s_cbranch_scc1 C_POB_X
    buffer_load_dword v120, v121, s[44:47], s93 offen sc1
    s_waitcnt vmcnt(0)
    s_add_u32 s39, s39, 1
    s_cmp_ge_u32 s39, 0x4000
    s_cbranch_scc1 C_POB_X
    s_mov_b32 s92, 0
    v_cmp_ne_u32 vcc, s40, v120
    s_cmp_lg_u64 vcc, 0
    s_cbranch_scc1 C_POB
    v_mov_b32 v2, 147476
    v_mov_b32 v3, s40
    ds_write_b32 v2, v3
    s_mov_b32 s92, 2
C_POB_X:
    s_mov_b32 s39, 0
C_PBc:
    s_barrier
    s_add_u32 s88, s88, 16384
    s_cmp_eq_u32 s88, 147456
    s_cselect_b32 s89, 0xfffe0000, s75
    s_cselect_b32 s88, 0, s88
    v_add_u32 v31, s89, v31
    v_add_u32 v32, s89, v32
    v_add_u32 v33, s89, v33
    v_add_u32 v34, s89, v34
    v_add_u32 v30, s89, v30
    s_waitcnt lgkmcnt(9)
    v_mfma_f32_32x32x16_bf16 v[148:163], v[164:167], v[168:171], v[148:163]
    ds_read_b128 v[196:199], v31
    ds_read_b64_tr_b16 v[200:201], v30 offset:0
    ds_read_b64_tr_b16 v[202:203], v30 offset:512
    s_waitcnt lgkmcnt(9)
    v_mfma_f32_32x32x16_bf16 v[148:163], v[172:175], v[176:179], v[148:163]
    ds_read_b128 v[204:207], v32
    ds_read_b64_tr_b16 v[208:209], v30 offset:2048
    ds_read_b64_tr_b16 v[210:211], v30 offset:2560
    s_waitcnt lgkmcnt(9)
    v_mfma_f32_32x32x16_bf16 v[148:163], v[180:183], v[184:187], v[148:163]
    ds_read_b128 v[212:215], v33
    ds_read_b64_tr_b16 v[216:217], v30 offset:4096
    ds_read_b64_tr_b16 v[218:219], v30 offset:4608
    s_waitcnt lgkmcnt(9)
    v_mfma_f32_32x32x16_bf16 v[148:163], v[188:191], v[192:195], v[148:163]
    ds_read_b128 v[220:223], v34
    ds_read_b64_tr_b16 v[224:225], v30 offset:6144
    ds_read_b64_tr_b16 v[226:227], v30 offset:6656
    s_barrier
    s_add_u32 s88, s88, 16384
    s_cmp_eq_u32 s88, 147456
    s_cselect_b32 s89, 0xfffe0000, s75
    s_cselect_b32 s88, 0, s88
    v_add_u32 v31, s89, v31
    v_add_u32 v32, s89, v32
    v_add_u32 v33, s89, v33
    v_add_u32 v34, s89, v34
    v_add_u32 v30, s89, v30
    s_waitcnt lgkmcnt(9)
    v_mfma_f32_32x32x16_bf16 v[148:163], v[196:199], v[200:203], v[148:163]
    ds_read_b128 v[164:167], v31
    ds_read_b64_tr_b16 v[168:169], v30 offset:0
    ds_read_b64_tr_b16 v[170:171], v30 offset:512
    s_waitcnt lgkmcnt(9)
    v_mfma_f32_32x32x16_bf16 v[148:163], v[204:207], v[208:211], v[148:163]
    ds_read_b128 v[172:175], v32
    ds_read_b64_tr_b16 v[176:177], v30 offset:2048
    ds_read_b64_tr_b16 v[178:179], v30 offset:2560
    s_waitcnt lgkmcnt(9)
    v_mfma_f32_32x32x16_bf16 v[148:163], v[212:215], v[216:219], v[148:163]
    ds_read_b128 v[180:183], v33
    ds_read_b64_tr_b16 v[184:185], v30 offset:4096
    ds_read_b64_tr_b16 v[186:187], v30 offset:4608
    s_waitcnt lgkmcnt(9)
    v_mfma_f32_32x32x16_bf16 v[148:163], v[220:223], v[224:227], v[148:163]
    ds_read_b128 v[188:191], v34
    ds_read_b64_tr_b16 v[192:193], v30 offset:6144
    ds_read_b64_tr_b16 v[194:195], v30 offset:6656
    s_add_u32 s39, s39, 2
    s_cmp_lt_u32 s39, 8
    s_cbranch_scc1 C_PBc
    s_barrier
    s_add_u32 s88, s88, 16384
    s_cmp_eq_u32 s88, 147456
    s_cselect_b32 s89, 0xfffe0000, s75
    s_cselect_b32 s88, 0, s88
    v_add_u32 v31, s89, v31
    v_add_u32 v32, s89, v32
    v_add_u32 v33, s89, v33
    v_add_u32 v34, s89, v34
    v_add_u32 v30, s89, v30
    s_waitcnt lgkmcnt(9)
    v_mfma_f32_32x32x16_bf16 v[148:163], v[164:167], v[168:171], v[148:163]
    ds_read_b128 v[196:199], v31
    ds_read_b64_tr_b16 v[200:201], v30 offset:0
    ds_read_b64_tr_b16 v[202:203], v30 offset:512
    s_waitcnt lgkmcnt(9)
    v_mfma_f32_32x32x16_bf16 v[148:163], v[172:175], v[176:179], v[148:163]
    ds_read_b128 v[204:207], v32
    ds_read_b64_tr_b16 v[208:209], v30 offset:2048
    ds_read_b64_tr_b16 v[210:211], v30 offset:2560
    s_waitcnt lgkmcnt(9)
    v_mfma_f32_32x32x16_bf16 v[148:163], v[180:183], v[184:187], v[148:163]
    ds_read_b128 v[212:215], v33
    ds_read_b64_tr_b16 v[216:217], v30 offset:4096
    ds_read_b64_tr_b16 v[218:219], v30 offset:4608
    s_waitcnt lgkmcnt(9)
    v_mfma_f32_32x32x16_bf16 v[148:163], v[188:191], v[192:195], v[148:163]
    ds_read_b128 v[220:223], v34
    ds_read_b64_tr_b16 v[224:225], v30 offset:6144
    ds_read_b64_tr_b16 v[226:227], v30 offset:6656
    s_barrier
    s_add_u32 s88, s88, 16384
    s_cmp_eq_u32 s88, 147456
    s_cselect_b32 s89, 0xfffe0000, s75
    s_cselect_b32 s88, 0, s88
    v_add_u32 v29, s88, v237
    v_add_u32 v35, s88, v232
    v_add_u32 v36, s88, v233
    v_add_u32 v37, s88, v234
    v_add_u32 v38, s88, v235
    s_waitcnt lgkmcnt(9)
    v_mfma_f32_32x32x16_bf16 v[148:163], v[196:199], v[200:203], v[148:163]
    ds_read_b64_tr_b16 v[164:165], v29 offset:0
    ds_read_b64_tr_b16 v[166:167], v29 offset:512
    ds_read_b128 v[168:171], v35
    s_waitcnt lgkmcnt(9)
    v_mfma_f32_32x32x16_bf16 v[148:163], v[204:207], v[208:211], v[148:163]
    ds_read_b64_tr_b16 v[172:173], v29 offset:2048
    ds_read_b64_tr_b16 v[174:175], v29 offset:2560
    ds_read_b128 v[176:179], v36
    s_waitcnt lgkmcnt(9)
    v_mfma_f32_32x32x16_bf16 v[148:163], v[212:215], v[216:219], v[148:163]
    ds_read_b64_tr_b16 v[180:181], v29 offset:4096
    ds_read_b64_tr_b16 v[182:183], v29 offset:4608
    ds_read_b128 v[184:187], v37
    s_waitcnt lgkmcnt(9)
    v_mfma_f32_32x32x16_bf16 v[148:163], v[220:223], v[224:227], v[148:163]
    ds_read_b64_tr_b16 v[188:189], v29 offset:6144
    ds_read_b64_tr_b16 v[190:191], v29 offset:6656
    ds_read_b128 v[192:195], v38
    s_mov_b32 s39, 0
C_PA:
    s_barrier
    s_add_u32 s88, s88, 16384
    s_cmp_eq_u32 s88, 147456
    s_cselect_b32 s89, 0xfffe0000, s75
    s_cselect_b32 s88, 0, s88
    v_add_u32 v29, s89, v29
    v_add_u32 v35, s89, v35
    v_add_u32 v36, s89, v36
    v_add_u32 v37, s89, v37
    v_add_u32 v38, s89, v38
    s_waitcnt lgkmcnt(9)
    v_mfma_f32_32x32x16_bf16 v[132:147], v[164:167], v[168:171], v[132:147]
    ds_read_b64_tr_b16 v[196:197], v29 offset:0
    ds_read_b64_tr_b16 v[198:199], v29 offset:512
    ds_read_b128 v[200:203], v35
    s_waitcnt lgkmcnt(9)
    v_mfma_f32_32x32x16_bf16 v[132:147], v[172:175], v[176:179], v[132:147]
    ds_read_b64_tr_b16 v[204:205], v29 offset:2048
    ds_read_b64_tr_b16 v[206:207], v29 offset:2560
    ds_read_b128 v[208:211], v36
    s_waitcnt lgkmcnt(9)
    v_mfma_f32_32x32x16_bf16 v[132:147], v[180:183], v[184:187], v[132:147]
    ds_read_b64_tr_b16 v[212:213], v29 offset:4096
    ds_read_b64_tr_b16 v[214:215], v29 offset:4608
    ds_read_b128 v[216:219], v37
    s_waitcnt lgkmcnt(9)
    v_mfma_f32_32x32x16_bf16 v[132:147], v[188:191], v[192:195], v[132:147]
    ds_read_b64_tr_b16 v[220:221], v29 offset:6144
    ds_read_b64_tr_b16 v[222:223], v29 offset:6656
    ds_read_b128 v[224:227], v38
    s_barrier
    s_add_u32 s88, s88, 16384
    s_cmp_eq_u32 s88, 147456
    s_cselect_b32 s89, 0xfffe0000, s75
    s_cselect_b32 s88, 0, s88
    v_add_u32 v29, s89, v29
    v_add_u32 v35, s89, v35
    v_add_u32 v36, s89, v36
    v_add_u32 v37, s89, v37
    v_add_u32 v38, s89, v38
    s_waitcnt lgkmcnt(9)
    v_mfma_f32_32x32x16_bf16 v[132:147], v[196:199], v[200:203], v[132:147]
    ds_read_b64_tr_b16 v[164:165], v29 offset:0
    ds_read_b64_tr_b16 v[166:167], v29 offset:512
    ds_read_b128 v[168:171], v35
    s_waitcnt lgkmcnt(9)
    v_mfma_f32_32x32x16_bf16 v[132:147], v[204:207], v[208:211], v[132:147]
    ds_read_b64_tr_b16 v[172:173], v29 offset:2048
    ds_read_b64_tr_b16 v[174:175], v29 offset:2560
    ds_read_b128 v[176:179], v36
    s_waitcnt lgkmcnt(9)
    v_mfma_f32_32x32x16_bf16 v[132:147], v[212:215], v[216:219], v[132:147]
    ds_read_b64_tr_b16 v[180:181], v29 offset:4096
    ds_read_b64_tr_b16 v[182:183], v29 offset:4608
    ds_read_b128 v[184:187], v37
    s_waitcnt lgkmcnt(9)
    v_mfma_f32_32x32x16_bf16 v[132:147], v[220:223], v[224:227], v[132:147]
    ds_read_b64_tr_b16 v[188:189], v29 offset:6144
    ds_read_b64_tr_b16 v[190:191], v29 offset:6656
    ds_read_b128 v[192:195], v38
    s_add_u32 s39, s39, 2
    s_cmp_lt_u32 s39, 6
    s_cbranch_scc1 C_PA
    s_barrier
    s_add_u32 s88, s88, 16384
    s_cmp_eq_u32 s88, 147456
    s_cselect_b32 s89, 0xfffe0000, s75
    s_cselect_b32 s88, 0, s88
    v_add_u32 v29, s89, v29
    v_add_u32 v35, s89, v35
    v_add_u32 v36, s89, v36
    v_add_u32 v37, s89, v37
    v_add_u32 v38, s89, v38
    s_waitcnt lgkmcnt(9)
    v_mfma_f32_32x32x16_bf16 v[132:147], v[164:167], v[168:171], v[132:147]
    ds_read_b64_tr_b16 v[196:197], v29 offset:0
    ds_read_b64_tr_b16 v[198:199], v29 offset:512
    ds_read_b128 v[200:203], v35
    s_waitcnt lgkmcnt(9)
    v_mfma_f32_32x32x16_bf16 v[132:147], v[172:175], v[176:179], v[132:147]
    ds_read_b64_tr_b16 v[204:205], v29 offset:2048
    ds_read_b64_tr_b16 v[206:207], v29 offset:2560
    ds_read_b128 v[208:211], v36
    s_waitcnt lgkmcnt(9)
    v_mfma_f32_32x32x16_bf16 v[132:147], v[180:183], v[184:187], v[132:147]
    ds_read_b64_tr_b16 v[212:213], v29 offset:4096
    ds_read_b64_tr_b16 v[214:215], v29 offset:4608
    ds_read_b128 v[216:219], v37
    s_waitcnt lgkmcnt(9)
    v_mfma_f32_32x32x16_bf16 v[132:147], v[188:191], v[192:195], v[132:147]
    ds_read_b64_tr_b16 v[220:221], v29 offset:6144
    ds_read_b64_tr_b16 v[222:223], v29 offset:6656
    ds_read_b128 v[224:227], v38
    s_waitcnt lgkmcnt(9)
    v_mfma_f32_32x32x16_bf16 v[132:147], v[196:199], v[200:203], v[132:147]
    s_waitcnt lgkmcnt(6)
    v_mfma_f32_32x32x16_bf16 v[132:147], v[204:207], v[208:211], v[132:147]
    s_waitcnt lgkmcnt(3)
    v_mfma_f32_32x32x16_bf16 v[132:147], v[212:215], v[216:219], v[132:147]
    s_waitcnt lgkmcnt(0)
    v_mfma_f32_32x32x16_bf16 v[132:147], v[220:223], v[224:227], v[132:147]
    s_waitcnt vmcnt(0) lgkmcnt(0)
    s_nop 7
    s_nop 7
    v_lshlrev_b32 v107, 16, v107
    v_sub_f32 v80, 1.0, v106
    v_cvt_pk_bf16_f32 v80, v80, v80
    v_lshlrev_b32 v80, 16, v80
    v_cvt_pk_bf16_f32 v72, v132, v133
    v_cvt_pk_bf16_f32 v73, v134, v135
    v_cvt_pk_bf16_f32 v74, v136, v137
    v_cvt_pk_bf16_f32 v75, v138, v139
    v_cvt_pk_bf16_f32 v76, v140, v141
    v_cvt_pk_bf16_f32 v77, v142, v143
    v_cvt_pk_bf16_f32 v78, v144, v145
    v_cvt_pk_bf16_f32 v79, v146, v147
    v_lshlrev_b32 v40, 16, v72
    v_and_b32 v41, 0xffff0000, v72
    v_lshlrev_b32 v42, 16, v73
    v_and_b32 v43, 0xffff0000, v73
    v_lshlrev_b32 v44, 16, v74
    v_and_b32 v45, 0xffff0000, v74
    v_lshlrev_b32 v46, 16, v75
    v_and_b32 v47, 0xffff0000, v75
    v_lshlrev_b32 v48, 16, v76
    v_and_b32 v49, 0xffff0000, v76
    v_lshlrev_b32 v50, 16, v77
    v_and_b32 v51, 0xffff0000, v77
    v_lshlrev_b32 v52, 16, v78
    v_and_b32 v53, 0xffff0000, v78
    v_lshlrev_b32 v54, 16, v79
    v_and_b32 v55, 0xffff0000, v79
    v_mul_f32 v40, v40, v106
    v_mul_f32 v41, v41, v106
    v_mul_f32 v42, v42, v106
    v_mul_f32 v43, v43, v106
    v_mul_f32 v44, v44, v106
    v_mul_f32 v45, v45, v106
    v_mul_f32 v46, v46, v106
    v_mul_f32 v47, v47, v106
    v_mul_f32 v48, v48, v106
    v_mul_f32 v49, v49, v106
    v_mul_f32 v50, v50, v106
    v_mul_f32 v51, v51, v106
    v_mul_f32 v52, v52, v106
    v_mul_f32 v53, v53, v106
    v_mul_f32 v54, v54, v106
    v_mul_f32 v55, v55, v106
    v_cvt_pk_bf16_f32 v72, v40, v41
    v_cvt_pk_bf16_f32 v73, v42, v43
    v_cvt_pk_bf16_f32 v74, v44, v45
    v_cvt_pk_bf16_f32 v75, v46, v47
    v_cvt_pk_bf16_f32 v76, v48, v49
    v_cvt_pk_bf16_f32 v77, v50, v51
    v_cvt_pk_bf16_f32 v78, v52, v53
    v_cvt_pk_bf16_f32 v79, v54, v55
    v_lshlrev_b32 v40, 16, v72
    v_and_b32 v41, 0xffff0000, v72
    v_lshlrev_b32 v42, 16, v73
    v_and_b32 v43, 0xffff0000, v73
    v_lshlrev_b32 v44, 16, v74
    v_and_b32 v45, 0xffff0000, v74
    v_lshlrev_b32 v46, 16, v75
    v_and_b32 v47, 0xffff0000, v75
    v_lshlrev_b32 v48, 16, v76
    v_and_b32 v49, 0xffff0000, v76
    v_lshlrev_b32 v50, 16, v77
    v_and_b32 v51, 0xffff0000, v77
    v_lshlrev_b32 v52, 16, v78
    v_and_b32 v53, 0xffff0000, v78
    v_lshlrev_b32 v54, 16, v79
    v_and_b32 v55, 0xffff0000, v79
    v_cvt_pk_bf16_f32 v72, v148, v149
    v_cvt_pk_bf16_f32 v73, v150, v151
    v_cvt_pk_bf16_f32 v74, v152, v153
    v_cvt_pk_bf16_f32 v75, v154, v155
    v_cvt_pk_bf16_f32 v76, v156, v157
    v_cvt_pk_bf16_f32 v77, v158, v159
    v_cvt_pk_bf16_f32 v78, v160, v161
    v_cvt_pk_bf16_f32 v79, v162, v163
    v_lshlrev_b32 v56, 16, v72
    v_and_b32 v57, 0xffff0000, v72
    v_lshlrev_b32 v58, 16, v73
    v_and_b32 v59, 0xffff0000, v73
    v_lshlrev_b32 v60, 16, v74
    v_and_b32 v61, 0xffff0000, v74
    v_lshlrev_b32 v62, 16, v75
    v_and_b32 v63, 0xffff0000, v75
    v_lshlrev_b32 v64, 16, v76
    v_and_b32 v65, 0xffff0000, v76
    v_lshlrev_b32 v66, 16, v77
    v_and_b32 v67, 0xffff0000, v77
    v_lshlrev_b32 v68, 16, v78
    v_and_b32 v69, 0xffff0000, v78
    v_lshlrev_b32 v70, 16, v79
    v_and_b32 v71, 0xffff0000, v79
    v_add_f32 v56, v56, v107
    v_add_f32 v57, v57, v107
    v_add_f32 v58, v58, v107
    v_add_f32 v59, v59, v107
    v_add_f32 v60, v60, v107
    v_add_f32 v61, v61, v107
    v_add_f32 v62, v62, v107
    v_add_f32 v63, v63, v107
    v_add_f32 v64, v64, v107
    v_add_f32 v65, v65, v107
    v_add_f32 v66, v66, v107
    v_add_f32 v67, v67, v107
    v_add_f32 v68, v68, v107
    v_add_f32 v69, v69, v107
    v_add_f32 v70, v70, v107
    v_add_f32 v71, v71, v107
    v_cvt_pk_bf16_f32 v72, v56, v57
    v_cvt_pk_bf16_f32 v73, v58, v59
    v_cvt_pk_bf16_f32 v74, v60, v61
    v_cvt_pk_bf16_f32 v75, v62, v63
    v_cvt_pk_bf16_f32 v76, v64, v65
    v_cvt_pk_bf16_f32 v77, v66, v67
    v_cvt_pk_bf16_f32 v78, v68, v69
    v_cvt_pk_bf16_f32 v79, v70, v71
    v_lshlrev_b32 v56, 16, v72
    v_and_b32 v57, 0xffff0000, v72
    v_lshlrev_b32 v58, 16, v73
    v_and_b32 v59, 0xffff0000, v73
    v_lshlrev_b32 v60, 16, v74
    v_and_b32 v61, 0xffff0000, v74
    v_lshlrev_b32 v62, 16, v75
    v_and_b32 v63, 0xffff0000, v75
    v_lshlrev_b32 v64, 16, v76
    v_and_b32 v65, 0xffff0000, v76
    v_lshlrev_b32 v66, 16, v77
    v_and_b32 v67, 0xffff0000, v77
    v_lshlrev_b32 v68, 16, v78
    v_and_b32 v69, 0xffff0000, v78
    v_lshlrev_b32 v70, 16, v79
    v_and_b32 v71, 0xffff0000, v79
    v_mul_f32 v56, v56, v80
    v_mul_f32 v57, v57, v80
    v_mul_f32 v58, v58, v80
    v_mul_f32 v59, v59, v80
    v_mul_f32 v60, v60, v80
    v_mul_f32 v61, v61, v80
    v_mul_f32 v62, v62, v80
    v_mul_f32 v63, v63, v80
    v_mul_f32 v64, v64, v80
    v_mul_f32 v65, v65, v80
    v_mul_f32 v66, v66, v80
    v_mul_f32 v67, v67, v80
    v_mul_f32 v68, v68, v80
    v_mul_f32 v69, v69, v80
    v_mul_f32 v70, v70, v80
    v_mul_f32 v71, v71, v80
    v_cvt_pk_bf16_f32 v72, v56, v57
    v_cvt_pk_bf16_f32 v73, v58, v59
    v_cvt_pk_bf16_f32 v74, v60, v61
    v_cvt_pk_bf16_f32 v75, v62, v63
    v_cvt_pk_bf16_f32 v76, v64, v65
    v_cvt_pk_bf16_f32 v77, v66, v67
    v_cvt_pk_bf16_f32 v78, v68, v69
    v_cvt_pk_bf16_f32 v79, v70, v71
    v_lshlrev_b32 v56, 16, v72
    v_and_b32 v57, 0xffff0000, v72
    v_lshlrev_b32 v58, 16, v73
    v_and_b32 v59, 0xffff0000, v73
    v_lshlrev_b32 v60, 16, v74
    v_and_b32 v61, 0xffff0000, v74
    v_lshlrev_b32 v62, 16, v75
    v_and_b32 v63, 0xffff0000, v75
    v_lshlrev_b32 v64, 16, v76
    v_and_b32 v65, 0xffff0000, v76
    v_lshlrev_b32 v66, 16, v77
    v_and_b32 v67, 0xffff0000, v77
    v_lshlrev_b32 v68, 16, v78
    v_and_b32 v69, 0xffff0000, v78
    v_lshlrev_b32 v70, 16, v79
    v_and_b32 v71, 0xffff0000, v79
    v_add_f32 v40, v40, v56
    v_add_f32 v41, v41, v57
    v_add_f32 v42, v42, v58
    v_add_f32 v43, v43, v59
    v_add_f32 v44, v44, v60
    v_add_f32 v45, v45, v61
    v_add_f32 v46, v46, v62
    v_add_f32 v47, v47, v63
    v_add_f32 v48, v48, v64
    v_add_f32 v49, v49, v65
    v_add_f32 v50, v50, v66
    v_add_f32 v51, v51, v67
    v_add_f32 v52, v52, v68
    v_add_f32 v53, v53, v69
    v_add_f32 v54, v54, v70
    v_add_f32 v55, v55, v71
    v_cvt_pk_bf16_f32 v132, v40, v41
    v_cvt_pk_bf16_f32 v133, v42, v43
    v_cvt_pk_bf16_f32 v134, v44, v45
    v_cvt_pk_bf16_f32 v135, v46, v47
    v_cvt_pk_bf16_f32 v136, v48, v49
    v_cvt_pk_bf16_f32 v137, v50, v51
    v_cvt_pk_bf16_f32 v138, v52, v53
    v_cvt_pk_bf16_f32 v139, v54, v55
    v_lshlrev_b32 v2, 10, v105
    v_lshrrev_b32 v3, 5, v1
    v_lshl_add_u32 v2, v3, 3, v2
    s_lshl_b32 s31, s35, 7
    s_lshl_b32 s32, s90, 6
    s_add_u32 s31, s31, s32
    buffer_store_dwordx2 v[132:133], v2, s[68:71], s31 offen offset:0
    buffer_store_dwordx2 v[134:135], v2, s[68:71], s31 offen offset:16
    buffer_store_dwordx2 v[136:137], v2, s[68:71], s31 offen offset:32
    buffer_store_dwordx2 v[138:139], v2, s[68:71], s31 offen offset:48
F_END:
    s_endpgm
.section .rodata,"a"
.p2align 6
.amdhsa_kernel gated_mix__sliding_local_dilated__mixer_token_mlp__prompt_kernel
  .amdhsa_next_free_vgpr 244
  .amdhsa_next_free_sgpr 100
  .amdhsa_accum_offset 244
  .amdhsa_group_segment_fixed_size 0
  .amdhsa_kernarg_size 96
  .amdhsa_user_sgpr_count 2
  .amdhsa_user_sgpr_kernarg_segment_ptr 1
  .amdhsa_system_sgpr_workgroup_id_x 1
.end_amdhsa_kernel
```
